```python
import torch

def _softmax(x, axis=-1):
    return torch.softmax(x, dim=axis)
def _gelu(x):
    return torch.nn.functional.gelu(x, approximate="tanh")
def _silu(x):
    return torch.nn.functional.silu(x)
def _sigmoid(x):
    return torch.sigmoid(x)
def _layernorm(x, axis=-1, eps=1e-5):
    m = x.mean(dim=axis, keepdim=True)
    v = x.var(dim=axis, keepdim=True, unbiased=False)
    return (x - m) / torch.sqrt(v + eps)
def _scatter_add(tgt, idx, src, axis=0):
    return tgt.clone().index_add_(axis, idx, src)
def _segment_sum(src, seg, n):
    out = torch.zeros((n,) + src.shape[1:], dtype=src.dtype)
    return out.index_add_(0, seg, src)
def _pad(x, pw):
    flat = tuple(v for pair in reversed(pw) for v in pair)
    return torch.nn.functional.pad(x, flat)

kernel_name = 'sequential_preLN__spectral_gfnet__moe_arch_mod__prompt'

def setup_inputs():

    _w = (lambda a: (lambda t: t.to(torch.bfloat16) if t.is_floating_point() else t)(torch.as_tensor(a)))
    def _A_setup():
        B, S, D = 1, 2048, 1024
        Df = D // 2 + 1
        return {
            "x": _w((lambda *s: torch.randn(*s, dtype=torch.bfloat16) * 0.05)(B, S, D)),
            "w_r": _w((lambda *s: torch.randn(*s, dtype=torch.bfloat16) * 1.6)(S, Df) * 0.02),
            "w_i": _w((lambda *s: torch.randn(*s, dtype=torch.bfloat16) * 1.6)(S, Df) * 0.02),
        }
    _A_in = _A_setup()

    def _B_setup():
        B, S, D, F, C = 1, 2048, 1024, 3584, 8
        return {
            "x": _w((lambda *s: torch.randn(*s, dtype=torch.bfloat16) * 0.05)(B, S, D)),
            "w_r": _w((lambda *s: torch.randn(*s, dtype=torch.bfloat16) * 0.2)(D)),
            "w_gate": _w((lambda *s: torch.randn(*s, dtype=torch.bfloat16) * 0.2)(D, F)),
            "w_up": _w((lambda *s: torch.randn(*s, dtype=torch.bfloat16) * 0.2)(D, F)),
            "w_down": _w((lambda *s: torch.randn(*s, dtype=torch.bfloat16) * 0.2)(F, D)),
        }
    _B_in = _B_setup()

    return {
        "A_x": _A_in["x"],
        "A_w_r": _A_in["w_r"],
        "A_w_i": _A_in["w_i"],
        "B_x": _B_in["x"],
        "B_w_r": _B_in["w_r"],
        "B_w_gate": _B_in["w_gate"],
        "B_w_up": _B_in["w_up"],
        "B_w_down": _B_in["w_down"],
    }

def reference(A_x, A_w_r, A_w_i, B_x, B_w_r, B_w_gate, B_w_up, B_w_down):
    def _A_ref(x, w_r, w_i):
        B, S, D = x.shape
        X = (lambda x, axes=(-2,-1): torch.fft.rfft2(x.float(), dim=axes))(x, axes=(-2, -1))
        W = w_r + 1j * w_i
        X = X * W
        y = (lambda x, s, axes=(-2,-1): torch.fft.irfft2(x, s=s, dim=axes).to(torch.bfloat16))(X, (S, D), axes=(-2, -1))
        return y

    def _B_ref(x, w_r, w_gate, w_up, w_down):
        B, S, D = x.shape
        C = 8
        r = x @ w_r
        idx = torch.argsort(-r, axis=-1)[:, :C]
        idx_e = (lambda x, n, axis: torch.repeat_interleave(x, n, dim=axis))(idx.reshape(B, C, 1), D, axis=2)
        x_sel = (lambda x, i, axis: torch.take_along_dim(x, i, dim=axis))(x, idx_e, axis=1)
        g = _silu(x_sel @ w_gate)
        u = x_sel @ w_up
        y = (g * u) @ w_down
        r_sel = _sigmoid((lambda x, i, axis: torch.take_along_dim(x, i, dim=axis))(r, idx, axis=1))
        y = y * r_sel.reshape(B, C, 1)
        b_off = (torch.arange(B) * S).reshape(B, 1)
        flat_idx = (idx + b_off).reshape(B * C)
        zero = (x * 0.0).reshape(B * S, D)
        upd = _scatter_add(zero, flat_idx, y.reshape(B * C, D), axis=0)
        return x + upd.reshape(B, S, D)

    x = A_x
    h = x + _A_ref(_layernorm(x, axis=-1), A_w_r, A_w_i)
    h2 = h + _B_ref(_layernorm(h, axis=-1), B_w_r, B_w_gate, B_w_up, B_w_down)
    return h2
```

```asm
; @launch grid=(256,1,1) block=(512,1,1) lds=156672
.amdgcn_target "amdgcn-amd-amdhsa--gfx950"
.text
.globl sequential_preLN__spectral_gfnet__moe_arch_mod__prompt_kernel
.p2align 8
.type sequential_preLN__spectral_gfnet__moe_arch_mod__prompt_kernel,@function
sequential_preLN__spectral_gfnet__moe_arch_mod__prompt_kernel:
    s_cmp_ge_u32 s2, 256
    s_cbranch_scc1 KP_EXIT
    s_nop 0
    s_load_dwordx16 s[8:23], s[0:1], 0
    s_load_dwordx2 s[4:5], s[0:1], 80
    s_load_dwordx2 s[24:25], s[0:1], 64
    s_mov_b32 s26, 4194304
    s_mov_b32 s27, 0x00020000
    s_mov_b32 s6, 20971520
    s_mov_b32 s7, 0x00020000
    s_getpc_b64 s[52:53]
K1_PC:
    s_lshr_b32 s41, s2, 3
    s_and_b32 s41, s41, 3
    v_mul_u32_u24 v15, 256, v0
    s_lshl_b32 s41, s41, 6
    v_add_u32 v15, s41, v15
    v_cmp_gt_u32 vcc, KP_EXIT-K1_PC, v15
    s_nop 0
    s_and_saveexec_b64 s[54:55], vcc
    s_cbranch_execz K1_NOPF
    global_load_dword v62, v15, s[52:53]
K1_NOPF:
    s_mov_b64 exec, -1
    s_and_b32 s36, s2, 7
    s_lshr_b32 s37, s2, 3
    s_lshl_b32 s38, s36, 5
    s_add_u32 s38, s38, s37
    v_and_b32 v1, 15, v0
    v_bfe_u32 v2, v0, 4, 2
    v_lshrrev_b32 v3, 6, v0
    v_lshlrev_b32 v9, 6, v1
    v_lshl_or_b32 v9, v2, 4, v9
    v_lshl_or_b32 v10, v3, 19, v9
    s_lshl_b32 s43, s38, 11
    v_and_b32 v4, 63, v0
    v_readfirstlane_b32 s39, v3
    s_mov_b32 s30, 4194304
    s_mov_b32 s31, 0x00020000
    s_waitcnt lgkmcnt(0)
    s_mov_b32 s28, s8
    s_mov_b32 s29, s9
    buffer_load_dwordx4 v[204:207], v10, s[28:31], s43 offen
    buffer_load_dwordx4 v[208:211], v10, s[28:31], s43 offen offset:1024
    s_mov_b32 s41, 4227072
    buffer_load_dwordx2 v[30:31], off, s[4:7], s41
    v_bfe_u32 v156, v3, 1, 1
    v_lshl_add_u32 v156, v156, 4, v1
    v_lshrrev_b32 v157, 2, v3
    v_lshl_add_u32 v157, v157, 2, v2
    v_lshlrev_b32 v157, 2, v157
    v_and_b32 v158, 1, v3
    v_cvt_f32_u32 v156, v156
    v_cvt_f32_u32 v157, v157
    v_cvt_f32_u32 v158, v158
    v_mul_f32 v156, 0x3a800000, v156
    v_mul_f32 v158, 0xbe800000, v158
    v_fma_f32 v160, v156, v157, v158
    v_lshlrev_b32 v159, 4, v0
    v_add_f32 v161, v160, v156
    v_fma_f32 v162, v156, 2.0, v160
    v_add_f32 v163, v162, v156
    v_cos_f32 v164, v160
    v_cos_f32 v165, v161
    v_cos_f32 v166, v162
    v_cos_f32 v167, v163
    ds_write_b128 v159, v[164:167] offset:16896
    v_lshrrev_b32 v38, 1, v1
    v_lshlrev_b32 v5, 2, v2
    v_sub_u32 v38, v38, v5
    v_and_b32 v6, 1, v1
    v_lshlrev_b32 v39, 4, v6
    v_mov_b32 v124, 0x3f80
    v_lshlrev_b32_e64 v39, v39, v124
    v_cmp_eq_u32 s[60:61], 0, v38
    v_cmp_eq_u32 s[62:63], 1, v38
    v_cmp_eq_u32 s[64:65], 2, v38
    v_cmp_eq_u32 s[66:67], 3, v38
    v_cndmask_b32 v124, 0, v39, s[60:61]
    v_cndmask_b32 v125, 0, v39, s[62:63]
    v_cndmask_b32 v126, 0, v39, s[64:65]
    v_cndmask_b32 v127, 0, v39, s[66:67]
    v_cmp_eq_u32 s[60:61], -8, v38
    v_cmp_eq_u32 s[62:63], -7, v38
    v_cmp_eq_u32 s[64:65], -6, v38
    v_cmp_eq_u32 s[66:67], -5, v38
    v_cndmask_b32 v128, 0, v39, s[60:61]
    v_cndmask_b32 v129, 0, v39, s[62:63]
    v_cndmask_b32 v130, 0, v39, s[64:65]
    v_cndmask_b32 v131, 0, v39, s[66:67]
    s_lshl_b32 s41, s37, 3
    s_add_u32 s41, s41, s39
    s_lshl_b32 s41, s41, 3
    s_add_u32 s41, s41, s36
    s_mul_i32 s41, s41, 1026
    s_and_b32 s41, s41, 0xffffffc0
    v_cmp_lt_u32 vcc, 17, v4
    v_subrev_u32 v15, 18, v4
    v_mov_b32 v188, s10
    v_cndmask_b32 v14, v4, v15, vcc
    v_mov_b32 v190, s12
    v_mov_b32 v189, s11
    v_mov_b32 v191, s13
    v_lshl_add_u32 v14, v14, 6, s41
    v_cndmask_b32 v188, v188, v190, vcc
    v_cndmask_b32 v189, v189, v191, vcc
    v_min_u32 v14, 2101244, v14
    s_lshl_b32 s41, s39, 8
    s_sub_u32 s41, s41, 2304
    s_mov_b32 exec_lo, 0
    s_mov_b32 exec_hi, 0xf0
    v_mov_b32 v188, s16
    v_mov_b32 v189, s17
    v_lshl_add_u32 v14, v4, 6, s41
    s_mov_b32 exec_lo, -1
    s_mov_b32 exec_hi, 255
    v_add_co_u32 v188, vcc, v188, v14
    s_nop 1
    v_addc_co_u32 v189, vcc, 0, v189, vcc
    global_load_dword v28, v[188:189], off
    s_mov_b64 exec, -1
    s_mov_b32 s28, s12
    s_mov_b32 s29, s13
    s_mov_b32 s30, 2101250
    v_and_b32 v16, 7, v0
    s_mul_i32 s44, s36, 7
    s_lshr_b32 s41, s37, 2
    s_add_u32 s44, s44, s41
    s_and_b32 s45, s37, 3
    v_lshrrev_b32 v14, 3, v4
    v_and_b32 v13, 2, v14
    v_xor_b32 v13, v13, v16
    v_and_b32_e64 v12, 3, v3
    v_lshl_add_u32 v14, v12, 6, v14
    v_mul_u32_u24 v12, 7168, v14
    v_lshl_add_u32 v12, v13, 4, v12
    v_xor_b32 v13, 64, v12
    s_mul_i32 s46, s45, 1835008
    s_lshl_b32 s41, s44, 7
    s_add_u32 s46, s46, s41
    s_cmp_ge_u32 s37, 28
    s_cselect_b32 s46, 0x40000000, s46
    s_cmp_ge_u32 s39, 4
    s_cselect_b32 s32, s20, s18
    s_cselect_b32 s33, s21, s19
    s_mov_b32 s34, 7340032
    s_mov_b32 s35, 0x00020000
    s_lshl_b32 s47, s39, 13
    s_add_u32 s47, s47, 58368
    s_mov_b32 m0, s47
    s_add_u32 s47, s47, 1024
    buffer_load_dwordx4 v12, s[32:35], s46 offen nt lds
    s_add_u32 s46, s46, 57344
    s_mov_b32 m0, s47
    s_add_u32 s47, s47, 1024
    buffer_load_dwordx4 v13, s[32:35], s46 offen nt lds
    s_add_u32 s46, s46, 57344
    v_cvt_f32_u32 v40, v1
    v_cvt_f32_u32_e64 v41, v5
    v_mul_f32 v40, 0x3d000000, v40
    v_mul_u32_u24 v42, 0x8000, v6
    v_lshl_or_b32 v42, v42, 16, v42
    v_add_f32 v46, 0x00000000, v41
    v_add_f32 v47, 0x3f800000, v41
    v_add_f32 v48, 0x40000000, v41
    v_add_f32 v49, 0x40400000, v41
    v_mul_f32 v92, v40, v46
    v_mul_f32 v93, v40, v47
    v_mul_f32 v94, v40, v48
    v_mul_f32 v95, v40, v49
    v_cos_f32 v96, v92
    v_sin_f32 v100, v92
    v_cos_f32 v97, v93
    v_sin_f32 v101, v93
    v_cos_f32 v98, v94
    v_sin_f32 v102, v94
    v_cos_f32 v99, v95
    v_sin_f32_e64 v103, v95
    v_cvt_pk_f16_f32 v132, v96, v97
    v_cvt_pk_f16_f32 v140, v100, v101
    v_cvt_pk_f16_f32 v133, v98, v99
    v_cvt_pk_f16_f32 v141, v102, v103
    v_xor_b32 v134, v132, v42
    v_xor_b32 v142, v140, v42
    v_xor_b32 v135, v133, v42
    v_xor_b32 v143, v141, v42
    v_xor_b32 v136, 0x80008000, v140
    v_xor_b32 v144, 0x80000000, v132
    v_xor_b32 v148, 0x00008000, v140
    v_xor_b32 v137, 0x80008000, v141
    v_xor_b32 v145, 0x80000000, v133
    v_xor_b32 v149, 0x00008000, v141
    v_xor_b32 v138, 0x80008000, v142
    v_xor_b32 v146, 0x80000000, v134
    v_xor_b32 v150, 0x00008000, v142
    v_xor_b32 v139, 0x80008000, v143
    v_xor_b32 v147, 0x80000000, v135
    v_xor_b32 v151, 0x00008000, v143
    v_lshrrev_b32 v92, 1, v1
    v_mul_u32_u24 v93, v92, v2
    v_lshl_add_u32 v93, v6, 1, v93
    v_lshl_add_u32 v94, v92, 2, v93
    v_cvt_f32_u32 v93, v93
    v_cvt_f32_u32 v94, v94
    v_mul_f32 v93, 0x3e000000, v93
    v_mul_f32 v94, 0x3e000000, v94
    v_cos_f32 v95, v93
    v_sin_f32 v96, v93
    v_cos_f32 v97, v94
    v_sin_f32 v98, v94
    v_cvt_pk_f16_f32 v152, v95, v96
    v_cvt_pk_f16_f32 v153, v97, v98
    v_lshlrev_b32_e64 v92, 4, v4
    s_waitcnt lgkmcnt(0)
    s_barrier
    ds_read_b128 v[156:159], v92 offset:16896
    ds_read_b128 v[172:175], v92 offset:17920
    ds_read_b128 v[160:163], v92 offset:18944
    ds_read_b128 v[176:179], v92 offset:19968
    ds_read_b128 v[164:167], v92 offset:20992
    ds_read_b128 v[180:183], v92 offset:22016
    ds_read_b128 v[168:171], v92 offset:23040
    ds_read_b128 v[184:187], v92 offset:24064
    v_cmp_eq_u32 vcc, 0, v4
    v_mov_b32 v154, 1.0
    v_mov_b32 v93, 0.5
    v_cndmask_b32 v154, v154, v93, vcc
    v_lshrrev_b32 v92, 2, v1
    v_and_b32 v93, 2, v1
    v_xor_b32 v92, v92, v93
    v_lshlrev_b32 v92, 4, v92
    v_and_b32_e64 v93, 3, v1
    v_lshl_or_b32 v92, v93, 6, v92
    v_lshl_or_b32 v92, v2, 9, v92
    v_mul_u32_u24 v18, 2112, v3
    v_add_u32 v18, v18, v92
    v_bfe_u32 v94, v1, 2, 1
    v_xor_b32 v92, v94, v3
    v_and_b32 v92, 1, v92
    v_lshrrev_b32 v95, 3, v1
    v_lshl_or_b32 v92, v92, 1, v95
    v_lshlrev_b32_e64 v92, 2, v92
    v_lshl_or_b32 v92, v93, 4, v92
    v_and_or_b32 v94, v3, 6, v94
    v_lshl_or_b32 v92, v94, 8, v92
    v_mul_u32_u24 v94, 2112, v2
    v_add_u32 v56, v92, v94
    v_add_u32 v57, 64, v56
    v_xor_b32 v92, 32, v92
    v_add_u32 v92, v92, v94
    v_add_u32 v58, 128, v92
    v_add_u32 v59, 192, v92
    v_lshl_add_u32 v96, v3, 4, v1
    v_add_u32 v96, 1, v96
    v_lshrrev_b32 v97, 4, v96
    v_bfe_u32 v98, v96, 2, 1
    v_xor_b32 v92, v98, v97
    v_and_b32 v92, 1, v92
    v_bfe_u32 v99, v96, 3, 1
    v_lshl_or_b32 v92, v92, 1, v99
    v_and_b32_e64 v96, 3, v96
    v_lshl_or_b32 v92, v96, 2, v92
    v_and_or_b32 v98, v97, 14, v98
    v_lshl_or_b32 v92, v98, 6, v92
    v_lshl_add_u32 v20, v92, 2, v94
    s_lshl_b32 s52, s38, 6
    s_mov_b32 s53, 524288
    v_lshl_add_u32 v92, v3, 1, v95
    v_and_b32 v95, 15, v92
    v_xor_b32_e64 v95, s38, v95
    v_lshl_add_u32 v92, v2, 5, v92
    v_lshl_or_b32 v92, v92, 8, v95
    v_lshl_or_b32 v92, v92, 3, v16
    v_lshlrev_b32 v17, 4, v92
    v_and_b32 v16, 7, v0
    s_lshl_b32 s42, s37, 3
    s_or_b32 s42, s42, s39
    s_cmp_lg_u32 s42, 248
    s_cselect_b32 s40, 0, 2
    s_cbranch_scc1 K1_NOWN
    v_lshl_add_u32 v14, v2, 6, v1
    v_mul_u32_u24 v14, 8208, v14
    s_mul_i32 s42, s36, 1026
    s_bitcmp0_b32 s36, 0
    s_cselect_b32 s41, 1024, 0
    s_add_u32 s42, s42, s41
    buffer_load_ushort v88, v14, s[28:31], s42 offen
    s_add_u32 s42, s42, 131328
    buffer_load_ushort v89, v14, s[28:31], s42 offen
    s_add_u32 s42, s42, 131328
    buffer_load_ushort v90, v14, s[28:31], s42 offen
    s_add_u32 s42, s42, 131328
    buffer_load_ushort v91, v14, s[28:31], s42 offen
    s_add_u32 s42, s42, 131328
    s_mov_b32 s28, s10
    s_mov_b32 s29, s11
    s_sub_u32 s42, s42, 525312
    buffer_load_ushort v84, v14, s[28:31], s42 offen
    s_add_u32 s42, s42, 131328
    buffer_load_ushort v85, v14, s[28:31], s42 offen
    s_add_u32 s42, s42, 131328
    buffer_load_ushort v86, v14, s[28:31], s42 offen
    s_add_u32 s42, s42, 131328
    buffer_load_ushort v87, v14, s[28:31], s42 offen
    s_add_u32 s42, s42, 131328
K1_NOWN:
    s_cmp_eq_u32 s40, 2
    s_waitcnt vmcnt(13)
    s_cbranch_scc1 K1_VW1
    s_waitcnt vmcnt(5)
K1_VW1:
    v_readfirstlane_b32 s56, v204
    s_nop 0
    s_lshl_b32 s56, s56, 16
    s_xor_b32 s41, s56, 0x80000000
    v_mov_b32 v46, s41
    v_mov_b32 v47, s41
    v_mov_b32 v48, s41
    v_mov_b32 v49, s41
    s_nop 1
    v_mfma_f32_16x16x32_bf16 v[228:231], v[204:207], v[124:127], v[46:49]
    v_mfma_f32_16x16x32_bf16 v[232:235], v[204:207], v[128:131], v[46:49]
    s_cmp_eq_u32 s40, 2
    s_waitcnt vmcnt(11)
    s_cbranch_scc1 K1_VW2
    s_waitcnt vmcnt(3)
K1_VW2:
    v_mfma_f32_16x16x32_bf16 v[236:239], v[208:211], v[124:127], v[46:49]
    v_mfma_f32_16x16x32_bf16 v[240:243], v[208:211], v[128:131], v[46:49]
    v_readfirstlane_b32 s14, v30
    v_readfirstlane_b32 s15, v31
    s_mov_b32 s49, 0x00030003
    s_mul_i32 s58, s14, 0x9e3779b1
    s_xor_b32 s58, s58, s15
    s_add_u32 s58, s58, 0x7f4a7c15
    s_lshr_b32 s41, s58, 15
    s_xor_b32 s58, s58, s41
    s_nop 0
    v_pk_add_f32 v[38:39], v[228:229], v[230:231]
    v_pk_mul_f32 v[40:41], v[228:229], v[228:229]
    v_pk_fma_f32 v[40:41], v[230:231], v[230:231], v[40:41]
    v_pk_add_f32 v[42:43], v[232:233], v[234:235]
    v_pk_mul_f32 v[44:45], v[232:233], v[232:233]
    v_pk_fma_f32 v[44:45], v[234:235], v[234:235], v[44:45]
    v_pk_add_f32 v[38:39], v[38:39], v[236:237]
    v_pk_fma_f32 v[40:41], v[236:237], v[236:237], v[40:41]
    v_pk_add_f32 v[38:39], v[38:39], v[238:239]
    v_pk_fma_f32 v[40:41], v[238:239], v[238:239], v[40:41]
    v_pk_add_f32 v[42:43], v[42:43], v[240:241]
    v_pk_fma_f32 v[44:45], v[240:241], v[240:241], v[44:45]
    v_pk_add_f32 v[42:43], v[42:43], v[242:243]
    v_pk_fma_f32 v[44:45], v[242:243], v[242:243], v[44:45]
    v_pk_add_f32 v[38:39], v[38:39], v[42:43]
    v_pk_add_f32 v[40:41], v[40:41], v[44:45]
    v_add_f32_e64 v38, v38, v39
    v_add_f32 v40, v40, v41
    s_nop 0
    v_add_f32_dpp v38, v38, v38 quad_perm:[1,0,3,2] row_mask:0xf bank_mask:0xf
    v_add_f32_dpp v40, v40, v40 quad_perm:[1,0,3,2] row_mask:0xf bank_mask:0xf
    s_mul_i32 s58, s58, 0x85ebca6b
    v_add_f32_dpp v38, v38, v38 quad_perm:[2,3,0,1] row_mask:0xf bank_mask:0xf
    v_add_f32_dpp v40, v40, v40 quad_perm:[2,3,0,1] row_mask:0xf bank_mask:0xf
    s_lshr_b32 s41, s58, 13
    v_add_f32_dpp v38, v38, v38 row_half_mirror row_mask:0xf bank_mask:0xf
    v_add_f32_dpp v40, v40, v40 row_half_mirror row_mask:0xf bank_mask:0xf
    s_xor_b32 s58, s58, s41
    v_add_f32_dpp v38, v38, v38 row_mirror row_mask:0xf bank_mask:0xf
    v_add_f32_dpp v40, v40, v40 row_mirror row_mask:0xf bank_mask:0xf
    s_mul_i32 s59, s58, 0xc2b2ae35
    v_add_f32_dpp v38, v38, v38 row_bcast:15 row_mask:0xa bank_mask:0xf
    v_add_f32_dpp v40, v40, v40 row_bcast:15 row_mask:0xa bank_mask:0xf
    s_lshr_b32 s41, s59, 16
    v_add_f32_dpp v38, v38, v38 row_bcast:31 row_mask:0xc bank_mask:0xf
    v_add_f32_dpp v40, v40, v40 row_bcast:31 row_mask:0xc bank_mask:0xf
    s_xor_b32 s59, s59, s41
    v_mul_f32 v38, 0x3a800000, v38
    v_mul_f32 v40, 0x3a800000, v40
    v_add_f32_e64 v42, s56, v38
    v_fma_f32 v40, -v38, v38, v40
    v_cvt_pk_bf16_f32 v42, v42, v40
    v_and_b32 v40, 0xffff0000, v42
    v_lshlrev_b32 v42, 16, v42
    v_add_f32 v40, 0x3727c5ac, v40
    v_sub_f32 v42, s56, v42
    v_cvt_pk_bf16_f32 v40, v40, v40
    v_and_b32 v40, 0xffff0000, v40
    v_sqrt_f32 v40, v40
    s_nop 0
    v_cvt_pk_bf16_f32 v40, v40, v40
    v_and_b32 v40, 0xffff0000, v40
    v_rcp_f32 v40, v40
    s_nop 0
    v_mul_f32_e64 v42, v42, v40
    v_readlane_b32 s54, v40, 63
    v_readlane_b32 s55, v42, 63
    s_nop 1
    s_nop 0
    v_pk_fma_f32 v[228:229], v[228:229], s[54:55], s[54:55] op_sel:[0,0,1] op_sel_hi:[1,0,1]
    v_pk_fma_f32 v[230:231], v[230:231], s[54:55], s[54:55] op_sel:[0,0,1] op_sel_hi:[1,0,1]
    v_pk_fma_f32 v[232:233], v[232:233], s[54:55], s[54:55] op_sel:[0,0,1] op_sel_hi:[1,0,1]
    v_pk_fma_f32 v[234:235], v[234:235], s[54:55], s[54:55] op_sel:[0,0,1] op_sel_hi:[1,0,1]
    v_pk_fma_f32 v[236:237], v[236:237], s[54:55], s[54:55] op_sel:[0,0,1] op_sel_hi:[1,0,1]
    v_pk_fma_f32 v[238:239], v[238:239], s[54:55], s[54:55] op_sel:[0,0,1] op_sel_hi:[1,0,1]
    v_pk_fma_f32 v[240:241], v[240:241], s[54:55], s[54:55] op_sel:[0,0,1] op_sel_hi:[1,0,1]
    v_pk_fma_f32 v[242:243], v[242:243], s[54:55], s[54:55] op_sel:[0,0,1] op_sel_hi:[1,0,1]
    v_cvt_pk_f16_f32 v76, v228, v229
    v_cvt_pk_f16_f32 v77, v230, v231
    v_cvt_pk_f16_f32 v78, v236, v237
    v_cvt_pk_f16_f32 v79, v238, v239
    v_cvt_pk_f16_f32 v80, v232, v233
    v_cvt_pk_f16_f32 v81, v234, v235
    v_cvt_pk_f16_f32 v82, v240, v241
    v_cvt_pk_f16_f32 v83, v242, v243
    v_mfma_f32_16x16x32_f16 v[92:95], v[76:79], v[132:135], 0
    s_waitcnt lgkmcnt(0)
    v_mov_b32 v15, s59
    v_mfma_f32_16x16x32_f16 v[96:99], v[76:79], v[136:139], 0
    v_lshlrev_b32_e64 v14, 3, v4
    v_alignbit_b32 v14, v15, s58, v14
    v_mfma_f32_16x16x32_f16 v[108:111], v[80:83], v[132:135], 0
    v_and_b32 v52, 0x00030002, v14
    v_lshrrev_b32 v53, 2, v14
    v_mfma_f32_16x16x32_f16 v[112:115], v[80:83], v[136:139], 0
    v_lshrrev_b32 v54, 4, v14
    v_lshrrev_b32 v55, 6, v14
    v_mfma_f32_16x16x32_f16 v[100:103], v[76:79], v[144:147], 0
    v_and_b32 v53, s49, v53
    v_and_b32 v54, 0x00030002, v54
    v_mfma_f32_16x16x32_f16 v[104:107], v[76:79], v[148:151], 0
    v_and_b32_e64 v55, s49, v55
    v_mfma_f32_16x16x32_f16 v[116:119], v[80:83], v[144:147], 0
    v_mfma_f32_16x16x32_f16 v[120:123], v[80:83], v[148:151], 0
    s_cmp_lg_u32 s39, 6
    s_cbranch_scc1 K1_NOSF
    v_mov_b32 v64, -1
    v_mov_b32 v65, -1
    v_lshlrev_b32 v14, 3, v4
    s_lshl_b32 s42, s2, 9
    s_add_u32 s42, s42, 13631488
    buffer_store_dwordx2 v[64:65], v14, s[4:7], s42 offen sc1
K1_NOSF:
    v_pk_mul_f32 v[188:189], v[92:93], v[156:157]
    v_pk_mul_f32 v[192:193], v[96:97], v[156:157]
    v_pk_mul_f32 v[190:191], v[94:95], v[158:159]
    v_pk_mul_f32 v[194:195], v[98:99], v[158:159]
    v_pk_fma_f32 v[188:189], v[96:97], v[172:173], v[188:189]
    v_pk_fma_f32 v[192:193], v[92:93], v[172:173], v[192:193] neg_lo:[1,0,0] neg_hi:[1,0,0]
    v_pk_fma_f32 v[190:191], v[98:99], v[174:175], v[190:191]
    v_pk_fma_f32 v[194:195], v[94:95], v[174:175], v[194:195] neg_lo:[1,0,0] neg_hi:[1,0,0]
    v_cvt_pk_f16_f32 v228, v188, v189
    v_cvt_pk_f16_f32 v232, v192, v193
    v_cvt_pk_f16_f32 v229, v190, v191
    v_cvt_pk_f16_f32 v233, v194, v195
    v_pk_mul_f32 v[196:197], v[108:109], v[164:165]
    v_pk_mul_f32 v[200:201], v[112:113], v[164:165]
    v_pk_mul_f32 v[198:199], v[110:111], v[166:167]
    v_pk_mul_f32 v[202:203], v[114:115], v[166:167]
    v_pk_fma_f32 v[196:197], v[112:113], v[180:181], v[196:197]
    v_pk_fma_f32 v[200:201], v[108:109], v[180:181], v[200:201] neg_lo:[1,0,0] neg_hi:[1,0,0]
    v_pk_fma_f32 v[198:199], v[114:115], v[182:183], v[198:199]
    v_pk_fma_f32 v[202:203], v[110:111], v[182:183], v[202:203] neg_lo:[1,0,0] neg_hi:[1,0,0]
    v_cvt_pk_f16_f32 v230, v196, v197
    v_cvt_pk_f16_f32 v234, v200, v201
    v_cvt_pk_f16_f32 v231, v198, v199
    v_cvt_pk_f16_f32 v235, v202, v203
    s_nop 0
    s_nop 0
    v_mfma_f32_16x16x32_f16 v[212:215], v[132:135], v[228:231], 0
    v_mfma_f32_16x16x32_f16 v[216:219], v[132:135], v[232:235], 0
    v_mfma_f32_16x16x32_f16 v[212:215], v[140:143], v[232:235], v[212:215]
    v_mfma_f32_16x16x32_f16 v[216:219], v[136:139], v[228:231], v[216:219]
    v_mfma_f32_16x16x32_f16 v[42:45], v[144:147], v[228:231], 0
    v_pk_mul_f32 v[188:189], v[100:101], v[160:161]
    v_pk_mul_f32 v[192:193], v[104:105], v[160:161]
    v_pk_mul_f32 v[190:191], v[102:103], v[162:163]
    v_pk_mul_f32 v[194:195], v[106:107], v[162:163]
    v_pk_fma_f32 v[188:189], v[104:105], v[176:177], v[188:189]
    v_pk_fma_f32 v[192:193], v[100:101], v[176:177], v[192:193] neg_lo:[1,0,0] neg_hi:[1,0,0]
    v_pk_fma_f32 v[190:191], v[106:107], v[178:179], v[190:191]
    v_pk_fma_f32 v[194:195], v[102:103], v[178:179], v[194:195] neg_lo:[1,0,0] neg_hi:[1,0,0]
    v_cvt_pk_f16_f32 v236, v188, v189
    v_cvt_pk_f16_f32 v240, v192, v193
    v_cvt_pk_f16_f32 v237, v190, v191
    v_cvt_pk_f16_f32 v241, v194, v195
    v_pk_mul_f32 v[196:197], v[116:117], v[168:169]
    v_pk_mul_f32 v[200:201], v[120:121], v[168:169]
    v_pk_mul_f32 v[198:199], v[118:119], v[170:171]
    v_pk_mul_f32 v[202:203], v[122:123], v[170:171]
    v_pk_fma_f32 v[196:197], v[120:121], v[184:185], v[196:197]
    v_pk_fma_f32 v[200:201], v[116:117], v[184:185], v[200:201] neg_lo:[1,0,0] neg_hi:[1,0,0]
    v_pk_fma_f32 v[198:199], v[122:123], v[186:187], v[198:199]
    v_pk_fma_f32 v[202:203], v[118:119], v[186:187], v[202:203] neg_lo:[1,0,0] neg_hi:[1,0,0]
    v_cvt_pk_f16_f32 v238, v196, v197
    v_cvt_pk_f16_f32 v242, v200, v201
    v_cvt_pk_f16_f32 v239, v198, v199
    v_cvt_pk_f16_f32 v243, v202, v203
    s_nop 0
    v_mfma_f32_16x16x32_f16 v[220:223], v[132:135], v[236:239], 0
    v_mfma_f32_16x16x32_f16 v[224:227], v[132:135], v[240:243], 0
    v_mfma_f32_16x16x32_f16 v[220:223], v[140:143], v[240:243], v[220:223]
    v_mfma_f32_16x16x32_f16 v[224:227], v[136:139], v[236:239], v[224:227]
    v_mul_f32 v212, v212, v154
    v_mul_f32_e64 v42, 0.5, v42
    v_cvt_pk_f16_f32 v92, v212, v216
    v_cvt_pk_f16_f32 v93, v213, v217
    v_cvt_pk_f16_f32 v94, v214, v218
    v_cvt_pk_f16_f32 v95, v215, v219
    v_cvt_pk_f16_f32 v42, v42, 0
    ds_write_b128 v18, v[92:95]
    s_mov_b64 exec, 1
    ds_write_b32 v18, v42 offset:2048
    s_mov_b64 exec, -1
    v_cvt_pk_f16_f32 v98, v220, v224
    v_cvt_pk_f16_f32 v99, v221, v225
    v_cvt_pk_f16_f32 v96, v222, v226
    v_cvt_pk_f16_f32 v97, v223, v227
    ds_write_b128 v18, v[96:99] offset:256
    s_waitcnt lgkmcnt(0)
    s_barrier
    ds_read2st64_b32 v[100:101], v56 offset0:0 offset1:33
    ds_read2st64_b32 v[102:103], v57 offset0:0 offset1:33
    ds_read2st64_b32 v[104:105], v58 offset0:0 offset1:33
    ds_read2st64_b32 v[106:107], v59 offset0:0 offset1:33
    ds_read2st64_b32 v[98:99], v20 offset0:0 offset1:33
    s_waitcnt lgkmcnt(4)
    v_mfma_f32_16x16x16_f16 v[108:111], v[152:153], v[100:101], 0
    s_waitcnt lgkmcnt(3)
    v_mfma_f32_16x16x16_f16 v[112:115], v[152:153], v[102:103], 0
    s_waitcnt lgkmcnt(2)
    v_mfma_f32_16x16x16_f16 v[116:119], v[152:153], v[104:105], 0
    s_waitcnt lgkmcnt(1)
    v_mfma_f32_16x16x16_f16 v[120:123], v[152:153], v[106:107], 0
    s_waitcnt lgkmcnt(0)
    v_mfma_f32_16x16x16_f16 v[38:41], v[152:153], v[98:99], 0
    v_cvt_pk_f16_f32 v228, v108, v109
    s_nop 0
    v_cvt_pk_f16_f32 v229, v112, v113
    s_nop 0
    v_cvt_pk_f16_f32 v230, v116, v117
    s_nop 0
    v_cvt_pk_f16_f32 v231, v120, v121
    v_bfi_b32 v228, s49, v52, v228
    v_bfi_b32 v229, s49, v53, v229
    v_bfi_b32 v230, s49, v54, v230
    v_bfi_b32 v231, s49, v55, v231
    buffer_store_dwordx4 v[228:231], v17, s[4:7], 0 offen sc1
    v_cvt_pk_f16_f32 v232, v114, v115
    v_cvt_pk_f16_f32 v233, v118, v119
    v_cvt_pk_f16_f32 v234, v122, v123
    v_cvt_pk_f16_f32 v235, v40, v41
    v_bfi_b32 v232, s49, v52, v232
    v_bfi_b32 v233, s49, v53, v233
    v_bfi_b32 v234, s49, v54, v234
    v_bfi_b32 v235, s49, v55, v235
    buffer_store_dwordx4 v[232:235], v17, s[4:7], s53 offen sc1
    v_mov_b32 v189, s58
    v_lshlrev_b32 v5, 4, v2
    s_add_u32 s41, s52, 4194304
    s_cmp_lg_u32 s39, 7
    s_cbranch_scc1 K1_NY0
    s_mov_b32 exec_lo, 0x80008000
    s_mov_b32 exec_hi, 0x80008000
    v_cvt_pk_f16_f32 v188, v38, v39
    buffer_store_dwordx2 v[188:189], v5, s[4:7], s41 offen sc1
K1_NY0:
    s_cmp_lg_u32 s39, 0
    s_cbranch_scc1 K1_NONY
    s_mov_b32 exec_lo, 0x00010001
    s_mov_b32 exec_hi, 0x00010001
    v_cvt_pk_f16_f32 v188, v110, v111
    buffer_store_dwordx2 v[188:189], v5, s[4:7], s41 offen offset:8 sc1
K1_NONY:
    s_mov_b64 exec, -1
    s_barrier
    s_mov_b32 s28, s16
    s_mov_b32 s29, s17
    s_mov_b32 s30, 2048
    s_mov_b32 s31, 0x00020000
    buffer_load_dwordx4 v[220:223], v9, s[28:31], 0 offen
    buffer_load_dwordx4 v[224:227], v9, s[28:31], 0 offen offset:1024
    s_mov_b32 m0, s47
    s_add_u32 s47, s47, 1024
    buffer_load_dwordx4 v12, s[32:35], s46 offen nt lds
    s_add_u32 s46, s46, 57344
    s_mov_b32 s30, 2101250
    s_barrier
    s_mov_b32 s40, 1
    s_cmp_ge_u32 s39, 4
    s_cbranch_scc1 KP_HI0
    v_bfe_u32 v5, v0, 1, 4
    v_bfe_u32 v6, v0, 5, 1
    v_and_b32 v7, 2, v3
    v_add_u32_e64 v6, v6, v7
    v_lshl_add_u32 v7, v6, 6, v5
    v_mul_u32_u24 v8, 8208, v7
    v_and_b32_e64 v7, 1, v0
    v_lshl_add_u32 v8, v7, 4, v8
    s_mul_i32 s60, s36, 1026
    s_add_u32 s60, s60, 2
    s_and_b32 s60, s60, -4
    s_lshl_b32 s41, s37, 5
    s_add_u32 s60, s60, s41
    s_add_u32 s61, s60, 131328
    s_add_u32 s62, s60, 262656
    s_add_u32 s63, s60, 393984
    s_bitcmp1_b32 s39, 0
    s_cselect_b32 s28, s12, s10
    s_cselect_b32 s29, s13, s11
    s_nop 0
    buffer_load_dwordx4 v[60:63], v8, s[28:31], s60 offen
    buffer_load_dwordx4 v[64:67], v8, s[28:31], s61 offen
    buffer_load_dwordx4 v[68:71], v8, s[28:31], s62 offen
    buffer_load_dwordx4 v[72:75], v8, s[28:31], s63 offen
    v_lshl_add_u32 v24, v6, 4, v5
    v_lshlrev_b32 v24, 4, v24
    v_mul_u32_u24 v7, 8256, v7
    v_add_u32 v24, v24, v7
    v_and_b32 v7, 1, v3
    v_mul_u32_u24 v7, 16512, v7
    v_add_u32 v24, v24, v7
    s_mov_b32 s40, 0
    s_lshl_b32 s41, s37, 3
    s_or_b32 s41, s41, s39
    s_cmp_lg_u32 s41, 248
    s_cbranch_scc1 KP_HI1
    s_mov_b32 s40, 2
    v_lshl_add_u32 v5, v2, 6, v1
    v_lshlrev_b32 v19, 6, v5
    s_lshl_b32 s64, s36, 3
    s_add_u32 s64, s64, 4194304
    s_branch KP_HI1
KP_HI0:
KP_HI1:
    s_cmp_eq_u32 s40, 0
    s_cbranch_scc1 KP_CONSTS
KP_K2C:
    v_lshlrev_b32 v6, 2, v2
    v_cvt_f32_u32 v172, v6
    v_cvt_f32_u32 v192, v1
    v_lshl_add_u32 v5, v1, 3, s36
    v_cvt_f32_u32 v193, v5
    v_cvt_f32_u32 v5, s36
    v_add_f32 v173, 0x3f800000, v172
    v_add_f32_e64 v174, 0x40000000, v172
    v_add_f32 v175, 0x40400000, v172
    s_mov_b32 s41, 0x41000000
    v_fma_f32 v176, v172, s41, v5
    v_fma_f32 v177, v173, s41, v5
    v_fma_f32 v178, v174, s41, v5
    v_fma_f32 v179, v175, s41, v5
    v_mul_f32 v6, 0x3c000000, v193
    v_mul_f32 v188, v6, v172
    v_mul_f32 v189, v6, v173
    v_mul_f32 v190, v6, v174
    v_mul_f32 v191, v6, v175
    v_cos_f32 v180, v188
    v_sin_f32 v184, v188
    v_cos_f32 v181, v189
    v_sin_f32 v185, v189
    v_cos_f32 v182, v190
    v_sin_f32 v186, v190
    v_cos_f32 v183, v191
    v_sin_f32 v187, v191
    v_cvt_pk_f16_f32 v124, v180, v184
    v_cvt_pk_f16_f32 v128, -v184, v180
    v_cvt_pk_f16_f32 v125, v181, v185
    v_cvt_pk_f16_f32 v129, -v185, v181
    v_cvt_pk_f16_f32 v126, v182, v186
    v_cvt_pk_f16_f32 v130, -v186, v182
    v_cvt_pk_f16_f32 v127, v183, v187
    v_cvt_pk_f16_f32 v131, -v187, v183
    v_mul_f32 v6, 0x3a000000, v193
    v_mul_f32 v188, v6, v172
    v_mul_f32 v189, v6, v173
    v_mul_f32 v190, v6, v174
    v_mul_f32 v191, v6, v175
    v_cos_f32 v156, v188
    v_sin_f32 v160, v188
    v_cos_f32 v157, v189
    v_sin_f32 v161, v189
    v_cos_f32 v158, v190
    v_sin_f32 v162, v190
    v_cos_f32 v159, v191
    v_sin_f32 v163, v191
    v_mul_f32 v156, 0x3d800000, v156
    v_mul_f32 v157, 0x3d800000, v157
    v_mul_f32 v158, 0x3d800000, v158
    v_mul_f32 v159, 0x3d800000, v159
    v_mul_f32 v160, 0x3d800000, v160
    v_mul_f32 v161, 0x3d800000, v161
    v_mul_f32 v162, 0x3d800000, v162
    v_mul_f32 v163, 0x3d800000, v163
    v_mul_f32 v6, 0x3d800000, v192
    v_mul_f32 v188, v6, v172
    v_mul_f32 v189, v6, v173
    v_mul_f32 v190, v6, v174
    v_mul_f32 v191, v6, v175
    v_cos_f32 v180, v188
    v_sin_f32 v184, v188
    v_cos_f32 v181, v189
    v_sin_f32 v185, v189
    v_cos_f32 v182, v190
    v_sin_f32 v186, v190
    v_cos_f32 v183, v191
    v_sin_f32 v187, v191
    v_cvt_pk_f16_f32 v132, v180, v184
    v_cvt_pk_f16_f32 v136, -v184, v180
    v_cvt_pk_bf16_f32 v140, v180, -v184
    v_cvt_pk_bf16_f32 v144, v184, v180
    v_cvt_pk_f16_f32 v133, v181, v185
    v_cvt_pk_f16_f32 v137, -v185, v181
    v_cvt_pk_bf16_f32 v141, v181, -v185
    v_cvt_pk_bf16_f32 v145, v185, v181
    v_cvt_pk_f16_f32 v134, v182, v186
    v_cvt_pk_f16_f32 v138, -v186, v182
    v_cvt_pk_bf16_f32 v142, v182, -v186
    v_cvt_pk_bf16_f32 v146, v186, v182
    v_cvt_pk_f16_f32 v135, v183, v187
    v_cvt_pk_f16_f32 v139, -v187, v183
    v_cvt_pk_bf16_f32 v143, v183, -v187
    v_cvt_pk_bf16_f32 v147, v187, v183
    v_mul_f32 v6, 0x3a000000, v192
    v_mul_f32 v188, v6, v176
    v_mul_f32 v189, v6, v177
    v_mul_f32 v190, v6, v178
    v_mul_f32 v191, v6, v179
    v_cos_f32 v164, v188
    v_sin_f32 v168, v188
    v_cos_f32 v165, v189
    v_sin_f32 v169, v189
    v_cos_f32 v166, v190
    v_sin_f32 v170, v190
    v_cos_f32 v167, v191
    v_sin_f32 v171, v191
    v_mul_f32 v164, 0x377fa056, v164
    v_mul_f32 v165, 0x377fa056, v165
    v_mul_f32 v166, 0x377fa056, v166
    v_mul_f32 v167, 0x377fa056, v167
    v_mul_f32 v168, 0x377fa056, v168
    v_mul_f32 v169, 0x377fa056, v169
    v_mul_f32 v170, 0x377fa056, v170
    v_mul_f32 v171, 0x377fa056, v171
    v_mul_f32 v6, 0x3c000000, v192
    v_mul_f32 v188, v6, v176
    v_mul_f32 v189, v6, v177
    v_mul_f32 v190, v6, v178
    v_mul_f32 v191, v6, v179
    v_cos_f32 v180, v188
    v_sin_f32 v184, v188
    v_cos_f32 v181, v189
    v_sin_f32 v185, v189
    v_cos_f32 v182, v190
    v_sin_f32 v186, v190
    v_cos_f32 v183, v191
    v_sin_f32 v187, v191
    v_cvt_pk_bf16_f32 v148, v180, -v184
    v_cvt_pk_bf16_f32 v152, v184, v180
    v_cvt_pk_bf16_f32 v149, v181, -v185
    v_cvt_pk_bf16_f32 v153, v185, v181
    v_cvt_pk_bf16_f32 v150, v182, -v186
    v_cvt_pk_bf16_f32 v154, v186, v182
    v_cvt_pk_bf16_f32 v151, v183, -v187
    v_cvt_pk_bf16_f32 v155, v187, v183
KP_X1:
    v_lshlrev_b32_e64 v5, 4, v4
    v_lshl_or_b32 v5, v3, 11, v5
    v_and_b32 v34, 0xffffffc0, v5
    v_add_u32 v34, v34, v5
    s_lshr_b32 s8, s38, 1
    s_and_b32 s42, s8, 15
    s_lshl_b32 s42, s42, 7
    s_and_b32 s41, s52, 64
    s_or_b32 s42, s42, s41
    v_xor_b32 v34, s42, v34
    v_xor_b32 v35, 0x800, v34
    s_lshl_b32 s8, s8, 15
    buffer_load_dwordx4 v[196:199], v34, s[4:7], s8 offen sc1
    buffer_load_dwordx4 v[200:203], v35, s[4:7], s8 offen sc1
    v_lshrrev_b32 v6, 3, v4
    v_lshrrev_b32 v7, 5, v4
    v_xor_b32 v6, v6, v7
    v_and_b32 v6, 3, v6
    v_lshlrev_b32 v6, 4, v6
    v_xor_b32 v36, v6, v5
    s_cmp_eq_u32 s40, 1
    s_cbranch_scc1 KP_NOWD
    s_cmp_eq_u32 s40, 0
    s_cbranch_scc1 KP_NONL
    buffer_load_dwordx2 v[212:213], v19, s[4:7], s64 offen offset:0 sc1
    buffer_load_dwordx2 v[214:215], v19, s[4:7], s64 offen offset:1024 sc1
    buffer_load_dwordx2 v[216:217], v19, s[4:7], s64 offen offset:2048 sc1
    buffer_load_dwordx2 v[218:219], v19, s[4:7], s64 offen offset:3072 sc1
KP_NONL:
    s_cmp_eq_u32 s40, 2
    s_waitcnt vmcnt(6)
    s_cbranch_scc1 K1_VW3
    s_waitcnt vmcnt(2)
K1_VW3:
    v_lshlrev_b32 v92, 16, v60
    v_lshlrev_b32 v93, 16, v64
    v_lshlrev_b32 v94, 16, v68
    v_lshlrev_b32 v95, 16, v72
    ds_write_b128 v24, v[92:95] offset:25088
    v_and_b32 v96, 0xffff0000, v60
    v_and_b32 v97, 0xffff0000, v64
    v_and_b32 v98, 0xffff0000, v68
    v_and_b32 v99, 0xffff0000, v72
    ds_write_b128 v24, v[96:99] offset:26112
    v_lshlrev_b32 v100, 16, v61
    v_lshlrev_b32 v101, 16, v65
    v_lshlrev_b32 v102, 16, v69
    v_lshlrev_b32 v103, 16, v73
    ds_write_b128 v24, v[100:103] offset:27136
    v_and_b32 v104, 0xffff0000, v61
    v_and_b32 v105, 0xffff0000, v65
    v_and_b32 v106, 0xffff0000, v69
    v_and_b32 v107, 0xffff0000, v73
    ds_write_b128 v24, v[104:107] offset:28160
    v_lshlrev_b32 v108, 16, v62
    v_lshlrev_b32 v109, 16, v66
    v_lshlrev_b32 v110, 16, v70
    v_lshlrev_b32 v111, 16, v74
    ds_write_b128 v24, v[108:111] offset:29184
    v_and_b32 v112, 0xffff0000, v62
    v_and_b32 v113, 0xffff0000, v66
    v_and_b32 v114, 0xffff0000, v70
    v_and_b32 v115, 0xffff0000, v74
    ds_write_b128 v24, v[112:115] offset:30208
    v_lshlrev_b32 v116, 16, v63
    v_lshlrev_b32 v117, 16, v67
    v_lshlrev_b32 v118, 16, v71
    v_lshlrev_b32 v119, 16, v75
    ds_write_b128 v24, v[116:119] offset:31232
    v_and_b32 v120, 0xffff0000, v63
    v_and_b32 v121, 0xffff0000, v67
    v_and_b32 v122, 0xffff0000, v71
    v_and_b32 v123, 0xffff0000, v75
    ds_write_b128 v24, v[120:123] offset:32256
    s_branch KP_X1C0
KP_NOWD:
    v_lshlrev_b32 v19, 6, v1
    v_lshl_or_b32 v19, v2, 12, v19
    v_lshrrev_b32 v6, 1, v1
    v_lshrrev_b32 v7, 3, v1
    v_xor_b32 v6, v6, v7
    v_xor_b32 v6, v6, v3
    v_and_b32_e64 v6, 3, v6
    v_lshl_or_b32 v19, v6, 4, v19
    v_bfe_u32 v6, v3, 1, 1
    v_mul_u32_u24 v20, 8256, v6
    v_and_b32_e64 v6, 1, v3
    v_lshl_add_u32 v20, v6, 12, v20
    v_lshl_add_u32 v20, v4, 4, v20
    s_setprio 1
KP_X1C0:
    s_mov_b32 s48, 0
    s_waitcnt vmcnt(0)
    v_xor_b32 v6, v196, v52
    v_xor_b32_e64 v7, v200, v52
    v_bitop3_b32 v6, v197, v53, v6 bitop3:0xbe
    v_bitop3_b32 v7, v201, v53, v7 bitop3:0xbe
    v_bitop3_b32 v6, v198, v54, v6 bitop3:0xbe
    v_bitop3_b32 v7, v202, v54, v7 bitop3:0xbe
    v_bitop3_b32 v6, v199, v55, v6 bitop3:0xbe
    v_bitop3_b32 v7, v203, v55, v7 bitop3:0xbe
    v_bitop3_b32 v6, v6, v7, s49 bitop3:0xa8
    v_cmp_ne_u32 s[50:51], 0, v6
    s_nop 0
    s_wqm_b64 s[50:51], s[50:51]
    s_cbranch_scc0 KP_X1P_DONE
KP_X1P_LOOP:
    s_mov_b64 exec, s[50:51]
    buffer_load_dwordx4 v[196:199], v34, s[4:7], s8 offen sc1
    buffer_load_dwordx4 v[200:203], v35, s[4:7], s8 offen sc1
    s_mov_b64 exec, -1
    s_add_u32 s48, s48, 1
    s_cmp_gt_u32 s48, 200000
    s_waitcnt vmcnt(0)
    s_cbranch_scc1 KP_X1P_DONE
    v_xor_b32 v6, v196, v52
    v_xor_b32 v7, v200, v52
    v_bitop3_b32 v6, v197, v53, v6 bitop3:0xbe
    v_bitop3_b32 v7, v201, v53, v7 bitop3:0xbe
    v_bitop3_b32 v6, v198, v54, v6 bitop3:0xbe
    v_bitop3_b32 v7, v202, v54, v7 bitop3:0xbe
    v_bitop3_b32 v6, v199, v55, v6 bitop3:0xbe
    v_bitop3_b32 v7, v203, v55, v7 bitop3:0xbe
    v_bitop3_b32 v6, v6, v7, s49 bitop3:0xa8
    v_cmp_ne_u32 s[50:51], 0, v6
    s_nop 0
    s_wqm_b64 s[50:51], s[50:51]
    s_cbranch_scc1 KP_X1P_LOOP
KP_X1P_DONE:
    s_mov_b32 s41, 0x00020002
    v_mov_b32 v6, s41
    v_bfi_b32 v228, s49, v6, v196
    v_bfi_b32 v229, s49, v6, v197
    v_bfi_b32 v230, s49, v6, v198
    v_bfi_b32 v231, s49, v6, v199
    ds_write_b128 v36, v[228:231] offset:0
    v_bfi_b32 v232, s49, v6, v200
    v_bfi_b32 v233, s49, v6, v201
    v_bfi_b32 v234, s49, v6, v202
    v_bfi_b32 v235, s49, v6, v203
    ds_write_b128 v36, v[232:235] offset:1024
    v_lshrrev_b32 v6, 2, v4
    v_xor_b32 v6, s38, v6
    v_and_b32 v6, 1, v6
    v_mul_u32_u24 v6, 192, v6
    v_xor_b32 v34, v34, v6
    v_xor_b32 v35, v35, v6
    v_xor_b32 v17, v17, v6
    s_waitcnt lgkmcnt(0)
    s_barrier
    s_cmp_eq_u32 s40, 1
    s_cbranch_scc1 KP_K2MATH
    s_cmp_eq_u32 s40, 2
    s_cbranch_scc1 KP_NYQM
    s_xor_b32 s62, s58, 0x5bd1e995
    s_cmp_lg_u32 s39, 1
    s_cbranch_scc1 KP_PF0
    v_mov_b32_e64 v5, s62
    v_lshlrev_b32 v6, 7, v4
    s_lshl_b32 s41, s38, 10
    s_add_u32 s41, s41, 4259840
    s_mov_b64 exec, 0xff
    buffer_store_dword v5, v6, s[4:7], s41 offen sc1
    s_mov_b64 exec, -1
KP_PF0:
    s_mov_b32 m0, s47
    s_add_u32 s47, s47, 1024
    buffer_load_dwordx4 v13, s[32:35], s46 offen nt lds
    s_add_u32 s46, s46, 57344
    s_mov_b32 m0, s47
    s_add_u32 s47, s47, 1024
    buffer_load_dwordx4 v12, s[32:35], s46 offen nt lds
    s_add_u32 s46, s46, 57344
    s_mov_b32 m0, s47
    s_add_u32 s47, s47, 1024
    buffer_load_dwordx4 v13, s[32:35], s46 offen nt lds
    s_add_u32 s46, s46, 57344
    s_mov_b32 s32, s20
    s_mov_b32 s33, s21
    s_sub_u32 s46, s46, 172032
    s_add_u32 s47, s47, 29696
    s_mov_b32 m0, s47
    s_add_u32 s47, s47, 1024
    buffer_load_dwordx4 v13, s[32:35], s46 offen nt lds
    s_add_u32 s46, s46, 57344
    s_mov_b32 m0, s47
    s_add_u32 s47, s47, 1024
    buffer_load_dwordx4 v12, s[32:35], s46 offen nt lds
    s_add_u32 s46, s46, 57344
    s_mov_b32 m0, s47
    s_add_u32 s47, s47, 1024
    buffer_load_dwordx4 v13, s[32:35], s46 offen nt lds
    s_add_u32 s46, s46, 57344
    s_mov_b32 s32, s18
    s_mov_b32 s33, s19
    s_sub_u32 s47, s47, 35840
    s_sub_u32 s46, s46, 172032
    s_cmp_lg_u32 s39, 1
    s_cbranch_scc1 KP_SYNCA
    s_xor_b32 s41, s41, 1024
    s_add_u32 s60, s4, s41
    s_addc_u32 s61, s5, 0
    s_sleep 8
    s_load_dword s42, s[60:61], 0
    s_waitcnt lgkmcnt(0)
    s_cmp_eq_u32 s42, s62
    s_cbranch_scc1 KP_SYNCA
    s_sleep 3
    s_load_dword s42, s[60:61], 128
    s_waitcnt lgkmcnt(0)
    s_cmp_eq_u32 s42, s62
    s_cbranch_scc1 KP_SYNCA
    s_sleep 3
    s_load_dword s42, s[60:61], 256
    s_waitcnt lgkmcnt(0)
    s_cmp_eq_u32 s42, s62
    s_cbranch_scc1 KP_SYNCA
    s_sleep 3
    s_load_dword s42, s[60:61], 384
    s_waitcnt lgkmcnt(0)
    s_cmp_eq_u32 s42, s62
    s_cbranch_scc1 KP_SYNCA
    s_sleep 3
    s_load_dword s42, s[60:61], 512
    s_waitcnt lgkmcnt(0)
    s_cmp_eq_u32 s42, s62
    s_cbranch_scc1 KP_SYNCA
    s_sleep 3
    s_load_dword s42, s[60:61], 640
    s_waitcnt lgkmcnt(0)
    s_cmp_eq_u32 s42, s62
    s_cbranch_scc1 KP_SYNCA
    s_sleep 3
    s_load_dword s42, s[60:61], 768
    s_waitcnt lgkmcnt(0)
    s_cmp_eq_u32 s42, s62
    s_cbranch_scc1 KP_SYNCA
    s_sleep 3
    s_mov_b32 s48, 0
    s_mov_b64 s[50:51], -1
KP_PF_LOOP:
    s_mov_b64 exec, s[50:51]
    buffer_load_dword v6, off, s[4:7], s41 offset:896 sc1
    s_mov_b64 exec, -1
    s_add_u32 s48, s48, 1
    s_cmp_gt_u32 s48, 200000
    s_waitcnt vmcnt(0)
    s_cbranch_scc1 KP_PF_DONE
    v_cmp_ne_u32 s[50:51], s62, v6
    s_nop 0
    s_cmp_lg_u64 s[50:51], 0
    s_cbranch_scc1 KP_PF_LOOP
KP_PF_DONE:
    s_branch KP_SYNCA
KP_NYQM:
    s_mov_b32 s48, 0
    s_branch KP_NYCHK
KP_NY_LOOP:
    buffer_load_dwordx2 v[212:213], v19, s[4:7], s64 offen offset:0 sc1
    buffer_load_dwordx2 v[214:215], v19, s[4:7], s64 offen offset:1024 sc1
    buffer_load_dwordx2 v[216:217], v19, s[4:7], s64 offen offset:2048 sc1
    buffer_load_dwordx2 v[218:219], v19, s[4:7], s64 offen offset:3072 sc1
KP_NYCHK:
    s_add_u32 s48, s48, 1
    s_cmp_gt_u32 s48, 200000
    s_waitcnt vmcnt(0)
    s_cbranch_scc1 KP_NY_DONE
    v_xor_b32_e64 v6, s58, v213
    v_bitop3_b32 v6, v215, s58, v6 bitop3:0xbe
    v_bitop3_b32 v6, v217, s58, v6 bitop3:0xbe
    v_bitop3_b32 v6, v219, s58, v6 bitop3:0xbe
    v_cmp_ne_u32 s[50:51], 0, v6
    s_nop 0
    s_cmp_lg_u64 s[50:51], 0
    s_cbranch_scc1 KP_NY_LOOP
KP_NY_DONE:
    v_mov_b32 v76, v212
    v_mov_b32 v77, v214
    v_mov_b32 v78, v216
    v_mov_b32 v79, v218
    s_nop 1
    v_mfma_f32_16x16x32_f16 v[92:95], v[76:79], v[124:127], 0
    v_mfma_f32_16x16x32_f16 v[96:99], v[76:79], v[128:131], 0
    v_lshlrev_b32 v84, 16, v84
    v_lshlrev_b32 v85, 16, v85
    v_lshlrev_b32 v86, 16, v86
    v_lshlrev_b32 v87, 16, v87
    v_lshlrev_b32 v88, 16, v88
    v_lshlrev_b32 v89, 16, v89
    v_lshlrev_b32 v90, 16, v90
    v_lshlrev_b32 v91, 16, v91
    v_pk_mul_f32 v[188:189], v[92:93], v[156:157]
    v_pk_mul_f32 v[192:193], v[96:97], v[156:157]
    v_pk_mul_f32 v[190:191], v[94:95], v[158:159]
    v_pk_mul_f32 v[194:195], v[98:99], v[158:159]
    v_pk_fma_f32 v[188:189], v[96:97], v[160:161], v[188:189]
    v_pk_fma_f32 v[192:193], v[92:93], v[160:161], v[192:193] neg_lo:[1,0,0] neg_hi:[1,0,0]
    v_pk_fma_f32 v[190:191], v[98:99], v[162:163], v[190:191]
    v_pk_fma_f32 v[194:195], v[94:95], v[162:163], v[194:195] neg_lo:[1,0,0] neg_hi:[1,0,0]
    v_cvt_pk_f16_f32 v76, v188, v192
    v_cvt_pk_f16_f32 v77, v189, v193
    v_cvt_pk_f16_f32 v78, v190, v194
    v_cvt_pk_f16_f32 v79, v191, v195
    s_nop 1
    v_mfma_f32_16x16x32_f16 v[92:95], v[132:135], v[76:79], 0
    v_mfma_f32_16x16x32_f16 v[96:99], v[136:139], v[76:79], 0
    s_nop 6
    v_pk_mul_f32 v[188:189], v[92:93], v[84:85]
    v_pk_mul_f32 v[192:193], v[96:97], v[84:85]
    v_pk_mul_f32 v[190:191], v[94:95], v[86:87]
    v_pk_mul_f32 v[194:195], v[98:99], v[86:87]
    v_pk_fma_f32 v[188:189], v[96:97], v[88:89], v[188:189] neg_lo:[1,0,0] neg_hi:[1,0,0]
    v_pk_fma_f32 v[192:193], v[92:93], v[88:89], v[192:193]
    v_pk_fma_f32 v[190:191], v[98:99], v[90:91], v[190:191] neg_lo:[1,0,0] neg_hi:[1,0,0]
    v_pk_fma_f32 v[194:195], v[94:95], v[90:91], v[194:195]
    v_cvt_pk_bf16_f32 v76, v188, v192
    v_cvt_pk_bf16_f32 v77, v189, v193
    v_cvt_pk_bf16_f32 v78, v190, v194
    v_cvt_pk_bf16_f32 v79, v191, v195
    s_nop 1
    v_mfma_f32_16x16x32_bf16 v[92:95], v[76:79], v[140:143], 0
    v_mfma_f32_16x16x32_bf16 v[96:99], v[76:79], v[144:147], 0
    s_nop 6
    v_pk_mul_f32 v[188:189], v[92:93], v[164:165]
    v_pk_mul_f32 v[192:193], v[96:97], v[164:165]
    v_pk_mul_f32 v[190:191], v[94:95], v[166:167]
    v_pk_mul_f32 v[194:195], v[98:99], v[166:167]
    v_pk_fma_f32 v[188:189], v[96:97], v[168:169], v[188:189] neg_lo:[1,0,0] neg_hi:[1,0,0]
    v_pk_fma_f32 v[192:193], v[92:93], v[168:169], v[192:193]
    v_pk_fma_f32 v[190:191], v[98:99], v[170:171], v[190:191] neg_lo:[1,0,0] neg_hi:[1,0,0]
    v_pk_fma_f32 v[194:195], v[94:95], v[170:171], v[194:195]
    v_cvt_pk_bf16_f32 v76, v188, v192
    v_cvt_pk_bf16_f32 v77, v189, v193
    v_cvt_pk_bf16_f32 v78, v190, v194
    v_cvt_pk_bf16_f32 v79, v191, v195
    s_nop 1
    v_mfma_f32_16x16x32_bf16 v[92:95], v[148:151], v[76:79], 0
    v_mfma_f32_16x16x32_bf16 v[96:99], v[152:155], v[76:79], 0
    v_lshlrev_b32 v5, 4, v4
    s_lshl_b32 s41, s36, 11
    s_add_u32 s41, s41, 4210688
    v_mov_b32 v84, s59
    v_mov_b32 v86, s59
    v_mov_b32 v88, s59
    v_mov_b32 v90, s59
    s_nop 0
    v_cvt_pk_bf16_f32 v85, v92, v96
    v_cvt_pk_bf16_f32 v87, v93, v97
    v_cvt_pk_bf16_f32 v89, v94, v98
    v_cvt_pk_bf16_f32 v91, v95, v99
    buffer_store_dwordx4 v[84:87], v5, s[4:7], s41 offen sc1
    buffer_store_dwordx4 v[88:91], v5, s[4:7], s41 offen offset:1024 sc1
    s_branch KP_SYNCA
KP_K2MATH:
    s_nop 0
    ds_read_b128 v[60:63], v19 offset:0
    ds_read_b128 v[64:67], v19 offset:1024
    ds_read_b128 v[68:71], v19 offset:2048
    ds_read_b128 v[72:75], v19 offset:3072
    ds_read_b128 v[172:175], v20 offset:25088
    ds_read_b128 v[176:179], v20 offset:41600
    ds_read_b128 v[180:183], v20 offset:26112
    ds_read_b128 v[184:187], v20 offset:42624
    ds_read_b128 v[76:79], v20 offset:27136
    ds_read_b128 v[80:83], v20 offset:43648
    ds_read_b128 v[84:87], v20 offset:28160
    ds_read_b128 v[88:91], v20 offset:44672
    s_waitcnt lgkmcnt(8)
    v_swap_b32 v61, v64
    v_swap_b32 v62, v68
    v_swap_b32 v63, v72
    v_swap_b32 v66, v69
    v_swap_b32 v67, v73
    v_mfma_f32_16x16x32_f16 v[92:95], v[60:63], v[124:127], 0
    v_mfma_f32_16x16x32_f16 v[96:99], v[60:63], v[128:131], 0
    v_swap_b32 v71, v74
    v_mfma_f32_16x16x32_f16 v[100:103], v[64:67], v[124:127], 0
    v_mfma_f32_16x16x32_f16 v[104:107], v[64:67], v[128:131], 0
    v_mfma_f32_16x16x32_f16 v[108:111], v[68:71], v[124:127], 0
    v_mfma_f32_16x16x32_f16 v[112:115], v[68:71], v[128:131], 0
    s_nop 1
    v_pk_mul_f32 v[188:189], v[92:93], v[156:157]
    v_pk_mul_f32 v[192:193], v[96:97], v[156:157]
    v_pk_mul_f32 v[190:191], v[94:95], v[158:159]
    v_pk_mul_f32 v[194:195], v[98:99], v[158:159]
    v_pk_fma_f32 v[188:189], v[96:97], v[160:161], v[188:189]
    v_pk_fma_f32 v[192:193], v[92:93], v[160:161], v[192:193] neg_lo:[1,0,0] neg_hi:[1,0,0]
    v_pk_fma_f32 v[190:191], v[98:99], v[162:163], v[190:191]
    v_pk_fma_f32 v[194:195], v[94:95], v[162:163], v[194:195] neg_lo:[1,0,0] neg_hi:[1,0,0]
    v_mfma_f32_16x16x32_f16 v[116:119], v[72:75], v[124:127], 0
    v_cvt_pk_f16_f32 v60, v188, v192
    v_cvt_pk_f16_f32 v61, v189, v193
    v_mfma_f32_16x16x32_f16 v[120:123], v[72:75], v[128:131], 0
    v_cvt_pk_f16_f32 v62, v190, v194
    v_cvt_pk_f16_f32 v63, v191, v195
    v_pk_mul_f32 v[228:229], v[100:101], v[156:157]
    v_pk_mul_f32 v[232:233], v[104:105], v[156:157]
    v_pk_mul_f32 v[230:231], v[102:103], v[158:159]
    v_pk_mul_f32 v[234:235], v[106:107], v[158:159]
    v_pk_fma_f32 v[228:229], v[104:105], v[160:161], v[228:229]
    v_pk_fma_f32 v[232:233], v[100:101], v[160:161], v[232:233] neg_lo:[1,0,0] neg_hi:[1,0,0]
    v_pk_fma_f32 v[230:231], v[106:107], v[162:163], v[230:231]
    v_pk_fma_f32 v[234:235], v[102:103], v[162:163], v[234:235] neg_lo:[1,0,0] neg_hi:[1,0,0]
    v_mfma_f32_16x16x32_f16 v[92:95], v[132:135], v[60:63], 0
    v_cvt_pk_f16_f32 v64, v228, v232
    v_cvt_pk_f16_f32 v65, v229, v233
    v_mfma_f32_16x16x32_f16 v[96:99], v[136:139], v[60:63], 0
    v_cvt_pk_f16_f32 v66, v230, v234
    v_cvt_pk_f16_f32 v67, v231, v235
    v_pk_mul_f32 v[188:189], v[108:109], v[156:157]
    v_pk_mul_f32 v[192:193], v[112:113], v[156:157]
    v_pk_mul_f32 v[190:191], v[110:111], v[158:159]
    v_pk_mul_f32 v[194:195], v[114:115], v[158:159]
    v_pk_fma_f32 v[188:189], v[112:113], v[160:161], v[188:189]
    v_pk_fma_f32 v[192:193], v[108:109], v[160:161], v[192:193] neg_lo:[1,0,0] neg_hi:[1,0,0]
    v_pk_fma_f32 v[190:191], v[114:115], v[162:163], v[190:191]
    v_pk_fma_f32 v[194:195], v[110:111], v[162:163], v[194:195] neg_lo:[1,0,0] neg_hi:[1,0,0]
    v_mfma_f32_16x16x32_f16 v[100:103], v[132:135], v[64:67], 0
    v_cvt_pk_f16_f32 v68, v188, v192
    v_cvt_pk_f16_f32 v69, v189, v193
    v_mfma_f32_16x16x32_f16 v[104:107], v[136:139], v[64:67], 0
    v_cvt_pk_f16_f32 v70, v190, v194
    v_cvt_pk_f16_f32 v71, v191, v195
    v_pk_mul_f32 v[228:229], v[116:117], v[156:157]
    v_pk_mul_f32 v[232:233], v[120:121], v[156:157]
    v_pk_mul_f32 v[230:231], v[118:119], v[158:159]
    v_pk_mul_f32 v[234:235], v[122:123], v[158:159]
    v_pk_fma_f32 v[228:229], v[120:121], v[160:161], v[228:229]
    v_pk_fma_f32 v[232:233], v[116:117], v[160:161], v[232:233] neg_lo:[1,0,0] neg_hi:[1,0,0]
    v_pk_fma_f32 v[230:231], v[122:123], v[162:163], v[230:231]
    v_pk_fma_f32 v[234:235], v[118:119], v[162:163], v[234:235] neg_lo:[1,0,0] neg_hi:[1,0,0]
    v_mfma_f32_16x16x32_f16 v[108:111], v[132:135], v[68:71], 0
    v_cvt_pk_f16_f32 v72, v228, v232
    v_cvt_pk_f16_f32 v73, v229, v233
    v_mfma_f32_16x16x32_f16 v[112:115], v[136:139], v[68:71], 0
    v_cvt_pk_f16_f32 v74, v230, v234
    v_cvt_pk_f16_f32 v75, v231, v235
    s_waitcnt lgkmcnt(0)
    s_nop 0
    v_pk_mul_f32 v[188:189], v[92:93], v[172:173]
    v_pk_mul_f32 v[192:193], v[96:97], v[172:173]
    v_pk_mul_f32 v[190:191], v[94:95], v[174:175]
    v_pk_mul_f32 v[194:195], v[98:99], v[174:175]
    v_pk_fma_f32 v[188:189], v[96:97], v[176:177], v[188:189] neg_lo:[1,0,0] neg_hi:[1,0,0]
    v_pk_fma_f32 v[192:193], v[92:93], v[176:177], v[192:193]
    v_pk_fma_f32 v[190:191], v[98:99], v[178:179], v[190:191] neg_lo:[1,0,0] neg_hi:[1,0,0]
    v_pk_fma_f32 v[194:195], v[94:95], v[178:179], v[194:195]
    v_mfma_f32_16x16x32_f16 v[116:119], v[132:135], v[72:75], 0
    v_cvt_pk_bf16_f32 v60, v188, v192
    v_cvt_pk_bf16_f32 v61, v189, v193
    v_mfma_f32_16x16x32_f16 v[120:123], v[136:139], v[72:75], 0
    v_cvt_pk_bf16_f32 v62, v190, v194
    v_cvt_pk_bf16_f32 v63, v191, v195
    v_pk_mul_f32 v[228:229], v[100:101], v[180:181]
    v_pk_mul_f32 v[232:233], v[104:105], v[180:181]
    v_pk_mul_f32 v[230:231], v[102:103], v[182:183]
    v_pk_mul_f32 v[234:235], v[106:107], v[182:183]
    v_pk_fma_f32 v[228:229], v[104:105], v[184:185], v[228:229] neg_lo:[1,0,0] neg_hi:[1,0,0]
    v_pk_fma_f32 v[232:233], v[100:101], v[184:185], v[232:233]
    v_pk_fma_f32 v[230:231], v[106:107], v[186:187], v[230:231] neg_lo:[1,0,0] neg_hi:[1,0,0]
    v_pk_fma_f32 v[234:235], v[102:103], v[186:187], v[234:235]
    v_mfma_f32_16x16x32_bf16 v[92:95], v[60:63], v[140:143], 0
    v_cvt_pk_bf16_f32 v64, v228, v232
    v_cvt_pk_bf16_f32 v65, v229, v233
    v_mfma_f32_16x16x32_bf16 v[96:99], v[60:63], v[144:147], 0
    v_cvt_pk_bf16_f32 v66, v230, v234
    v_cvt_pk_bf16_f32 v67, v231, v235
    v_pk_mul_f32 v[188:189], v[108:109], v[76:77]
    v_pk_mul_f32 v[192:193], v[112:113], v[76:77]
    v_pk_mul_f32 v[190:191], v[110:111], v[78:79]
    v_pk_mul_f32 v[194:195], v[114:115], v[78:79]
    v_pk_fma_f32 v[188:189], v[112:113], v[80:81], v[188:189] neg_lo:[1,0,0] neg_hi:[1,0,0]
    v_pk_fma_f32 v[192:193], v[108:109], v[80:81], v[192:193]
    v_pk_fma_f32 v[190:191], v[114:115], v[82:83], v[190:191] neg_lo:[1,0,0] neg_hi:[1,0,0]
    v_pk_fma_f32 v[194:195], v[110:111], v[82:83], v[194:195]
    v_mfma_f32_16x16x32_bf16 v[100:103], v[64:67], v[140:143], 0
    v_cvt_pk_bf16_f32 v68, v188, v192
    v_cvt_pk_bf16_f32 v69, v189, v193
    v_mfma_f32_16x16x32_bf16 v[104:107], v[64:67], v[144:147], 0
    v_cvt_pk_bf16_f32 v70, v190, v194
    v_cvt_pk_bf16_f32 v71, v191, v195
    v_pk_mul_f32 v[228:229], v[116:117], v[84:85]
    v_pk_mul_f32 v[232:233], v[120:121], v[84:85]
    v_pk_mul_f32 v[230:231], v[118:119], v[86:87]
    v_pk_mul_f32 v[234:235], v[122:123], v[86:87]
    v_pk_fma_f32 v[228:229], v[120:121], v[88:89], v[228:229] neg_lo:[1,0,0] neg_hi:[1,0,0]
    v_pk_fma_f32 v[232:233], v[116:117], v[88:89], v[232:233]
    v_pk_fma_f32 v[230:231], v[122:123], v[90:91], v[230:231] neg_lo:[1,0,0] neg_hi:[1,0,0]
    v_pk_fma_f32 v[234:235], v[118:119], v[90:91], v[234:235]
    v_mfma_f32_16x16x32_bf16 v[108:111], v[68:71], v[140:143], 0
    v_cvt_pk_bf16_f32 v72, v228, v232
    v_cvt_pk_bf16_f32 v73, v229, v233
    v_mfma_f32_16x16x32_bf16 v[112:115], v[68:71], v[144:147], 0
    v_cvt_pk_bf16_f32 v74, v230, v234
    v_cvt_pk_bf16_f32 v75, v231, v235
    v_pk_mul_f32 v[188:189], v[92:93], v[164:165]
    v_pk_mul_f32 v[192:193], v[96:97], v[164:165]
    v_pk_mul_f32 v[190:191], v[94:95], v[166:167]
    v_pk_mul_f32 v[194:195], v[98:99], v[166:167]
    v_pk_fma_f32 v[188:189], v[96:97], v[168:169], v[188:189] neg_lo:[1,0,0] neg_hi:[1,0,0]
    v_pk_fma_f32 v[192:193], v[92:93], v[168:169], v[192:193]
    v_pk_fma_f32 v[190:191], v[98:99], v[170:171], v[190:191] neg_lo:[1,0,0] neg_hi:[1,0,0]
    v_pk_fma_f32 v[194:195], v[94:95], v[170:171], v[194:195]
    v_mfma_f32_16x16x32_bf16 v[116:119], v[72:75], v[140:143], 0
    v_cvt_pk_bf16_f32 v60, v188, v192
    v_cvt_pk_bf16_f32 v61, v189, v193
    v_mfma_f32_16x16x32_bf16 v[120:123], v[72:75], v[144:147], 0
    v_cvt_pk_bf16_f32 v62, v190, v194
    v_cvt_pk_bf16_f32 v63, v191, v195
    v_pk_mul_f32 v[228:229], v[100:101], v[164:165]
    v_pk_mul_f32 v[232:233], v[104:105], v[164:165]
    v_pk_mul_f32 v[230:231], v[102:103], v[166:167]
    v_pk_mul_f32 v[234:235], v[106:107], v[166:167]
    v_pk_fma_f32 v[228:229], v[104:105], v[168:169], v[228:229] neg_lo:[1,0,0] neg_hi:[1,0,0]
    v_pk_fma_f32 v[232:233], v[100:101], v[168:169], v[232:233]
    v_pk_fma_f32 v[230:231], v[106:107], v[170:171], v[230:231] neg_lo:[1,0,0] neg_hi:[1,0,0]
    v_pk_fma_f32 v[234:235], v[102:103], v[170:171], v[234:235]
    v_mfma_f32_16x16x32_bf16 v[92:95], v[148:151], v[60:63], 0
    v_cvt_pk_bf16_f32 v64, v228, v232
    v_cvt_pk_bf16_f32 v65, v229, v233
    v_mfma_f32_16x16x32_bf16 v[96:99], v[152:155], v[60:63], 0
    v_cvt_pk_bf16_f32 v66, v230, v234
    v_cvt_pk_bf16_f32 v67, v231, v235
    v_pk_mul_f32 v[188:189], v[108:109], v[164:165]
    v_pk_mul_f32 v[192:193], v[112:113], v[164:165]
    v_pk_mul_f32 v[190:191], v[110:111], v[166:167]
    v_pk_mul_f32 v[194:195], v[114:115], v[166:167]
    v_pk_fma_f32 v[188:189], v[112:113], v[168:169], v[188:189] neg_lo:[1,0,0] neg_hi:[1,0,0]
    v_pk_fma_f32 v[192:193], v[108:109], v[168:169], v[192:193]
    v_pk_fma_f32 v[190:191], v[114:115], v[170:171], v[190:191] neg_lo:[1,0,0] neg_hi:[1,0,0]
    v_pk_fma_f32 v[194:195], v[110:111], v[170:171], v[194:195]
    v_mfma_f32_16x16x32_bf16 v[100:103], v[148:151], v[64:67], 0
    v_cvt_pk_bf16_f32 v68, v188, v192
    v_cvt_pk_bf16_f32 v69, v189, v193
    v_mfma_f32_16x16x32_bf16 v[104:107], v[152:155], v[64:67], 0
    v_cvt_pk_bf16_f32 v70, v190, v194
    v_cvt_pk_bf16_f32 v71, v191, v195
    v_pk_mul_f32 v[228:229], v[116:117], v[164:165]
    v_pk_mul_f32 v[232:233], v[120:121], v[164:165]
    v_pk_mul_f32 v[230:231], v[118:119], v[166:167]
    v_pk_mul_f32 v[234:235], v[122:123], v[166:167]
    v_pk_fma_f32 v[228:229], v[120:121], v[168:169], v[228:229] neg_lo:[1,0,0] neg_hi:[1,0,0]
    v_pk_fma_f32 v[232:233], v[116:117], v[168:169], v[232:233]
    v_pk_fma_f32 v[230:231], v[122:123], v[170:171], v[230:231] neg_lo:[1,0,0] neg_hi:[1,0,0]
    v_pk_fma_f32 v[234:235], v[118:119], v[170:171], v[234:235]
    v_mfma_f32_16x16x32_bf16 v[108:111], v[148:151], v[68:71], 0
    v_cvt_pk_bf16_f32 v72, v228, v232
    v_cvt_pk_bf16_f32 v73, v229, v233
    v_mfma_f32_16x16x32_bf16 v[112:115], v[152:155], v[68:71], 0
    v_cvt_pk_bf16_f32 v74, v230, v234
    v_cvt_pk_bf16_f32 v75, v231, v235
    v_cvt_pk_bf16_f32 v76, v92, v96
    v_cvt_pk_bf16_f32 v80, v93, v97
    v_mfma_f32_16x16x32_bf16 v[116:119], v[148:151], v[72:75], 0
    v_cvt_pk_bf16_f32 v84, v94, v98
    v_cvt_pk_bf16_f32 v88, v95, v99
    v_mfma_f32_16x16x32_bf16 v[120:123], v[152:155], v[72:75], 0
    v_cvt_pk_bf16_f32 v77, v100, v104
    v_cvt_pk_bf16_f32 v81, v101, v105
    v_cvt_pk_bf16_f32 v85, v102, v106
    v_cvt_pk_bf16_f32 v89, v103, v107
    v_cvt_pk_bf16_f32 v78, v108, v112
    v_cvt_pk_bf16_f32 v82, v109, v113
    v_cvt_pk_bf16_f32 v86, v110, v114
    v_cvt_pk_bf16_f32 v90, v111, v115
    v_cvt_pk_bf16_f32 v79, v116, v120
    v_cvt_pk_bf16_f32 v83, v117, v121
    v_cvt_pk_bf16_f32 v87, v118, v122
    v_cvt_pk_bf16_f32 v91, v119, v123
    ds_write_b128 v19, v[76:79] offset:0
    ds_write_b128 v19, v[80:83] offset:1024
    ds_write_b128 v19, v[84:87] offset:2048
    ds_write_b128 v19, v[88:91] offset:3072
KP_SYNCA:
    s_setprio 0
    s_waitcnt lgkmcnt(0)
    s_barrier
    ds_read_b128 v[188:191], v36 offset:0
    ds_read_b128 v[192:195], v36 offset:1024
    s_waitcnt lgkmcnt(1)
    v_or_b32 v188, 1, v188
    v_or_b32 v190, 1, v190
    buffer_store_dwordx4 v[188:191], v34, s[4:7], s8 offen sc1
    s_waitcnt lgkmcnt(0)
    v_or_b32 v192, 1, v192
    v_or_b32_e64 v194, 1, v194
    buffer_store_dwordx4 v[192:195], v35, s[4:7], s8 offen sc1
    s_add_u32 s46, s46, 172032
    s_add_u32 s47, s47, 3072
    s_mov_b32 m0, s47
    s_add_u32 s47, s47, 1024
    buffer_load_dwordx4 v12, s[32:35], s46 offen nt lds
    s_add_u32 s46, s46, 57344
    s_cmp_eq_u32 s40, 0
    s_cbranch_scc1 KP_PREPOLL
KP_CONSTS:
    v_and_b32 v38, 1, v1
    v_lshrrev_b32 v92, 1, v1
    v_mul_u32_u24 v93, v92, v2
    v_sub_u32 v93, v38, v93
    v_lshlrev_b32 v93, 1, v93
    v_sub_u32 v94, v93, v92
    v_cvt_f32_i32 v93, v93
    v_cvt_f32_i32_e64 v94, v94
    v_mul_f32 v93, 0x3e000000, v93
    v_mul_f32 v94, 0x3e000000, v94
    v_cos_f32 v95, v93
    v_sin_f32 v96, v93
    v_cos_f32 v97, v94
    v_sin_f32 v98, v94
    v_cvt_pk_bf16_f32 v26, v95, v96
    v_cvt_pk_bf16_f32 v27, v97, v98
    v_lshrrev_b32 v92, 1, v3
    v_lshlrev_b32 v92, 6, v92
    v_lshl_add_u32 v92, v1, 4, v92
    v_lshl_add_u32 v92, v3, 8, v92
    v_lshlrev_b32 v23, 12, v2
    v_mul_u32_u24 v21, 4608, v2
    v_add_u32 v18, v92, v21
    v_mul_u32_u24 v20, 2304, v3
    v_mul_u32_u24 v92, 576, v2
    v_lshl_add_u32 v92, v1, 2, v92
    v_add_u32 v19, v92, v20
    v_add_u32 v19, 25088, v19
    v_lshlrev_b32 v92, 2, v2
    v_cvt_f32_u32 v92, v92
    v_and_b32 v93, 12, v1
    v_add_u32 v93, v93, v1
    v_cvt_f32_u32 v40, v93
    v_mul_f32 v40, 0x3d000000, v40
    v_add_f32 v41, 0x3e000000, v40
    v_cvt_f32_u32_e64 v42, v1
    v_mul_f32 v42, 0x3d000000, v42
    v_mul_u32_u24 v43, 0x8000, v38
    v_lshl_or_b32 v43, v43, 16, v43
    v_lshlrev_b32 v22, 31, v38
    v_or_b32 v22, 1.0, v22
    v_cmp_eq_u32 vcc, 0, v2
    s_nop 1
    v_cndmask_b32 v22, 0, v22, vcc
    v_add_f32 v228, 0x00000000, v92
    v_add_f32 v229, 0x3f800000, v92
    v_add_f32 v230, 0x40000000, v92
    v_add_f32 v231, 0x40400000, v92
    v_add_f32 v232, 0x41800000, v92
    v_add_f32 v233, 0x41880000, v92
    v_add_f32 v234, 0x41900000, v92
    v_add_f32 v235, 0x41980000, v92
    v_mul_f32 v92, v40, v228
    v_mul_f32 v93, v40, v229
    v_mul_f32 v94, v40, v230
    v_mul_f32 v95, v40, v231
    v_mul_f32 v96, v41, v228
    v_mul_f32 v97, v41, v229
    v_mul_f32 v98, v41, v230
    v_mul_f32 v99, v41, v231
    v_mul_f32 v100, v42, v228
    v_mul_f32 v101, v42, v229
    v_mul_f32 v102, v42, v230
    v_mul_f32 v103, v42, v231
    v_cos_f32 v104, v92
    v_sin_f32 v92, v92
    v_cos_f32 v105, v93
    v_sin_f32 v93, v93
    v_cos_f32 v106, v94
    v_sin_f32 v94, v94
    v_cos_f32 v107, v95
    v_sin_f32 v95, v95
    v_cos_f32 v108, v96
    v_sin_f32 v96, v96
    v_cos_f32 v109, v97
    v_sin_f32 v97, v97
    v_cos_f32 v110, v98
    v_sin_f32 v98, v98
    v_cos_f32 v111, v99
    v_sin_f32 v99, v99
    v_cos_f32 v112, v100
    v_sin_f32 v100, v100
    v_cos_f32 v113, v101
    v_sin_f32 v101, v101
    v_cos_f32 v114, v102
    v_sin_f32 v102, v102
    v_cos_f32 v115, v103
    v_sin_f32 v103, v103
    v_cvt_pk_bf16_f32 v124, v104, -v92
    v_cvt_pk_bf16_f32 v128, v92, v104
    v_cvt_pk_bf16_f32 v125, v105, -v93
    v_cvt_pk_bf16_f32 v129, v93, v105
    v_cvt_pk_bf16_f32 v126, v106, -v94
    v_cvt_pk_bf16_f32 v130, v94, v106
    v_cvt_pk_bf16_f32 v127, v107, -v95
    v_cvt_pk_bf16_f32 v131, v95, v107
    v_cvt_pk_bf16_f32 v132, v108, -v96
    v_cvt_pk_bf16_f32 v136, v96, v108
    v_cvt_pk_bf16_f32 v133, v109, -v97
    v_cvt_pk_bf16_f32 v137, v97, v109
    v_cvt_pk_bf16_f32 v134, v110, -v98
    v_cvt_pk_bf16_f32 v138, v98, v110
    v_cvt_pk_bf16_f32 v135, v111, -v99
    v_cvt_pk_bf16_f32 v139, v99, v111
    v_cvt_pk_bf16_f32 v140, v112, -v100
    v_cvt_pk_bf16_f32 v141, v113, -v101
    v_cvt_pk_bf16_f32 v142, v114, -v102
    v_cvt_pk_bf16_f32 v143, v115, -v103
    v_xor_b32 v144, v140, v43
    v_xor_b32 v145, v141, v43
    v_xor_b32 v146, v142, v43
    v_xor_b32 v147, v143, v43
    v_mov_b32 v148, v140
    v_xor_b32 v149, 0x80008000, v141
    v_mov_b32 v150, v142
    v_xor_b32 v151, 0x80008000, v143
    v_mov_b32 v152, v144
    v_xor_b32 v153, 0x80008000, v145
    v_mov_b32 v154, v146
    v_xor_b32 v155, 0x80008000, v147
    v_mul_f32 v40, 0x3d000000, v40
    v_mul_f32 v41, 0x3d000000, v41
    v_mul_f32 v92, v40, v228
    v_mul_f32 v93, v40, v229
    v_mul_f32 v94, v40, v230
    v_mul_f32 v95, v40, v231
    v_mul_f32 v96, v40, v232
    v_mul_f32 v97, v40, v233
    v_mul_f32 v98, v40, v234
    v_mul_f32 v99, v40, v235
    v_mul_f32 v100, v41, v228
    v_mul_f32 v101, v41, v229
    v_mul_f32 v102, v41, v230
    v_mul_f32 v103, v41, v231
    v_mul_f32 v104, v41, v232
    v_mul_f32 v105, v41, v233
    v_mul_f32 v106, v41, v234
    v_mul_f32 v107, v41, v235
    v_cos_f32 v156, v92
    v_sin_f32 v172, v92
    v_cos_f32 v157, v93
    v_sin_f32 v173, v93
    v_cos_f32 v158, v94
    v_sin_f32 v174, v94
    v_cos_f32 v159, v95
    v_sin_f32 v175, v95
    v_cos_f32 v160, v96
    v_sin_f32 v176, v96
    v_cos_f32 v161, v97
    v_sin_f32 v177, v97
    v_cos_f32 v162, v98
    v_sin_f32 v178, v98
    v_cos_f32 v163, v99
    v_sin_f32 v179, v99
    v_cos_f32 v164, v100
    v_sin_f32 v180, v100
    v_cos_f32 v165, v101
    v_sin_f32 v181, v101
    v_cos_f32 v166, v102
    v_sin_f32 v182, v102
    v_cos_f32 v167, v103
    v_sin_f32 v183, v103
    v_cos_f32 v168, v104
    v_sin_f32 v184, v104
    v_cos_f32 v169, v105
    v_sin_f32 v185, v105
    v_cos_f32 v170, v106
    v_sin_f32 v186, v106
    v_cos_f32 v171, v107
    v_sin_f32 v187, v107
    v_mov_b32 v92, 0
    v_and_b32 v93, 28, v0
    ds_write_b32 v93, v92 offset:58144
    s_cmp_eq_u32 s40, 0
    s_cbranch_scc1 KP_X1
    s_sleep 6
    s_branch KP_POLL
KP_PREPOLL:
    s_sleep 30
KP_POLL:
    s_lshr_b32 s41, s38, 6
    s_lshl_b32 s41, s41, 8
    s_and_b32 s42, s38, 15
    s_lshl_b32 s42, s42, 4
    s_add_u32 s41, s41, s42
    s_bfe_u32 s42, s38, 0x10004
    s_lshl_b32 s42, s42, 3
    s_add_u32 s41, s41, s42
    s_bfe_u32 s42, s38, 0x10005
    s_lshl_b32 s42, s42, 10
    s_add_u32 s41, s41, s42
    s_add_u32 s54, s41, 4210688
    v_mov_b32 v30, s59
    v_mov_b32 v31, 0
    s_lshl_b32 s41, s39, 1
    s_sub_u32 s41, s41, 1
    s_add_u32 s55, s41, 16
    s_lshl_b32 s55, s55, 15
    s_and_b32 s41, s41, 15
    s_or_b32 s42, s38, 1
    s_xor_b32 s41, s41, s42
    s_lshl_b32 s41, s41, 7
    s_add_u32 s55, s55, s41
    s_and_b32 s41, s52, 64
    s_add_u32 s55, s55, s41
    s_add_u32 s55, s55, 56
    s_add_u32 s41, s54, 2048
    s_cmp_eq_u32 s39, 0
    s_cselect_b32 s55, s41, s55
    s_cselect_b32 s60, s59, 1
    s_cselect_b32 s61, -1, 1
    s_cselect_b32 s41, 12, 20
    v_lshlrev_b32 v8, s41, v2
    buffer_load_dwordx4 v[84:87], v17, s[4:7], 0 offen sc1
    buffer_load_dwordx4 v[88:91], v17, s[4:7], s53 offen sc1
    buffer_load_dwordx2 v[28:29], v8, s[4:7], s55 offen sc1
    s_cmp_lg_u32 s39, 7
    s_cbranch_scc1 KP_ZL1
    buffer_load_dwordx2 v[30:31], v23, s[4:7], s54 offen sc1
KP_ZL1:
    s_mov_b32 s41, 0x3f803f80
    v_dot2_f32_bf16 v25, v220, s41, 0
    v_dot2_f32_bf16 v25, v221, s41, v25
    v_dot2_f32_bf16 v25, v222, s41, v25
    v_dot2_f32_bf16 v25, v223, s41, v25
    v_dot2_f32_bf16 v25, v224, s41, v25
    v_dot2_f32_bf16 v25, v225, s41, v25
    v_dot2_f32_bf16 v25, v226, s41, v25
    v_dot2_f32_bf16 v25, v227, s41, v25
    v_lshlrev_b32 v196, 16, v204
    v_and_b32 v197, 0xffff0000, v204
    v_lshlrev_b32 v198, 16, v205
    v_and_b32 v199, 0xffff0000, v205
    v_add_f32_dpp v25, v25, v25 quad_perm:[1,0,3,2] row_mask:0xf bank_mask:0xf
    v_lshlrev_b32 v200, 16, v206
    v_and_b32 v201, 0xffff0000, v206
    v_lshlrev_b32 v202, 16, v207
    v_add_f32_dpp v25, v25, v25 quad_perm:[2,3,0,1] row_mask:0xf bank_mask:0xf
    v_and_b32 v203, 0xffff0000, v207
    v_lshlrev_b32_e64 v204, 16, v208
    v_and_b32 v205, 0xffff0000, v208
    v_add_f32_dpp v25, v25, v25 row_half_mirror row_mask:0xf bank_mask:0xf
    v_lshlrev_b32 v206, 16, v209
    v_and_b32 v207, 0xffff0000, v209
    v_lshlrev_b32 v208, 16, v210
    v_add_f32_dpp v25, v25, v25 row_mirror row_mask:0xf bank_mask:0xf
    v_and_b32 v209, 0xffff0000, v210
    v_lshlrev_b32_e64 v210, 16, v211
    v_and_b32 v211, 0xffff0000, v211
    v_add_f32_dpp v25, v25, v25 row_bcast:15 row_mask:0xa bank_mask:0xf
    v_lshlrev_b32 v212, 16, v220
    v_and_b32 v213, 0xffff0000, v220
    v_lshlrev_b32 v214, 16, v221
    v_add_f32_dpp v25, v25, v25 row_bcast:31 row_mask:0xc bank_mask:0xf
    v_and_b32 v215, 0xffff0000, v221
    v_lshlrev_b32 v216, 16, v222
    v_and_b32 v217, 0xffff0000, v222
    v_lshlrev_b32 v218, 16, v223
    v_and_b32 v219, 0xffff0000, v223
    v_lshlrev_b32 v220, 16, v224
    v_and_b32 v221, 0xffff0000, v224
    v_lshlrev_b32 v222, 16, v225
    v_and_b32 v223, 0xffff0000, v225
    v_lshlrev_b32 v224, 16, v226
    v_and_b32 v225, 0xffff0000, v226
    v_lshlrev_b32 v226, 16, v227
    v_and_b32 v227, 0xffff0000, v227
    v_pk_add_f32 v[196:197], v[196:197], s[56:57] op_sel_hi:[1,0] neg_lo:[0,1] neg_hi:[0,1]
    v_pk_add_f32 v[198:199], v[198:199], s[56:57] op_sel_hi:[1,0] neg_lo:[0,1] neg_hi:[0,1]
    v_pk_add_f32 v[200:201], v[200:201], s[56:57] op_sel_hi:[1,0] neg_lo:[0,1] neg_hi:[0,1]
    v_pk_add_f32 v[202:203], v[202:203], s[56:57] op_sel_hi:[1,0] neg_lo:[0,1] neg_hi:[0,1]
    v_pk_add_f32 v[204:205], v[204:205], s[56:57] op_sel_hi:[1,0] neg_lo:[0,1] neg_hi:[0,1]
    v_pk_add_f32 v[206:207], v[206:207], s[56:57] op_sel_hi:[1,0] neg_lo:[0,1] neg_hi:[0,1]
    v_pk_add_f32 v[208:209], v[208:209], s[56:57] op_sel_hi:[1,0] neg_lo:[0,1] neg_hi:[0,1]
    v_pk_add_f32 v[210:211], v[210:211], s[56:57] op_sel_hi:[1,0] neg_lo:[0,1] neg_hi:[0,1]
    s_mov_b32 s48, 0
    s_waitcnt vmcnt(0)
    v_bitop3_b32 v5, v84, v86, v88 bitop3:0x80
    v_xor_b32 v6, s60, v28
    v_bitop3_b32 v5, v5, v90, 1 bitop3:0x80
    v_and_b32 v6, s61, v6
    v_bitop3_b32 v6, v30, s59, v6 bitop3:0xbe
    v_cmp_ne_u32 vcc, 0, v6
    v_cmp_eq_u32 s[50:51], 0, v5
    s_nop 0
    s_or_b64 s[50:51], s[50:51], vcc
    s_cbranch_scc0 KP_Z_DONE
KP_Z_LOOP:
    s_mov_b64 exec, s[50:51]
    buffer_load_dwordx4 v[84:87], v17, s[4:7], 0 offen sc1
    buffer_load_dwordx4 v[88:91], v17, s[4:7], s53 offen sc1
    buffer_load_dwordx2 v[28:29], v8, s[4:7], s55 offen sc1
    s_cmp_lg_u32 s39, 7
    s_cbranch_scc1 KP_Z_L1
    buffer_load_dwordx2 v[30:31], v23, s[4:7], s54 offen sc1
KP_Z_L1:
    s_mov_b64 exec, -1
    s_add_u32 s48, s48, 1
    s_cmp_gt_u32 s48, 200000
    s_waitcnt vmcnt(0)
    s_cbranch_scc1 KP_Z_DONE
    v_bitop3_b32 v5, v84, v86, v88 bitop3:0x80
    v_xor_b32 v6, s60, v28
    v_bitop3_b32 v5, v5, v90, 1 bitop3:0x80
    v_and_b32 v6, s61, v6
    v_bitop3_b32 v6, v30, s59, v6 bitop3:0xbe
    v_cmp_ne_u32 vcc, 0, v6
    v_cmp_eq_u32 s[50:51], 0, v5
    s_nop 0
    s_or_b64 s[50:51], s[50:51], vcc
    s_cbranch_scc1 KP_Z_LOOP
KP_Z_DONE:
    v_mov_b32 v237, v29
    v_mov_b32 v238, v85
    v_mov_b32 v239, v88
    v_mov_b32 v236, v84
    v_mov_b32_dpp v237, v91 row_shr:1 row_mask:0xf bank_mask:0xf
    v_and_b32 v240, -2, v86
    v_mov_b32 v241, v89
    v_mov_b32 v242, v87
    v_and_b32 v243, -2, v90
    v_mov_b32 v32, v31
    v_mov_b32_e64 v33, v91
    v_mfma_f32_16x16x16_bf16 v[92:95], v[26:27], v[236:237], 0
    v_mfma_f32_16x16x16_bf16 v[96:99], v[26:27], v[238:239], 0
    v_mfma_f32_16x16x16_bf16 v[100:103], v[26:27], v[240:241], 0
    v_mfma_f32_16x16x16_bf16 v[104:107], v[26:27], v[242:243], 0
    v_mfma_f32_16x16x16_bf16 v[108:111], v[26:27], v[32:33], 0
    s_nop 3
    s_nop 0
    v_cvt_pk_bf16_f32 v112, v92, v93
    v_cvt_pk_bf16_f32 v113, v96, v97
    v_cvt_pk_bf16_f32 v114, v100, v101
    v_cvt_pk_bf16_f32 v115, v104, v105
    ds_write_b128 v18, v[112:115] offset:25088
    v_cvt_pk_bf16_f32 v116, v94, v95
    v_cvt_pk_bf16_f32 v117, v98, v99
    v_cvt_pk_bf16_f32 v118, v102, v103
    v_cvt_pk_bf16_f32 v119, v106, v107
    ds_write_b128 v18, v[116:119] offset:27392
    s_cmp_lg_u32 s39, 7
    s_cbranch_scc1 KP_NONY
    s_mov_b32 exec_lo, 0x80008000
    s_mov_b32 exec_hi, 0x80008000
    ds_write_b32 v21, v108 offset:25600
    ds_write_b32 v21, v110 offset:27904
    s_mov_b64 exec, -1
KP_NONY:
    s_waitcnt lgkmcnt(0)
    s_barrier
    s_nop 0
    ds_read2_b32 v[236:237], v19 offset0:0 offset1:32
    ds_read2_b32 v[238:239], v19 offset0:64 offset1:96
    ds_read2_b32 v[240:241], v19 offset0:16 offset1:48
    ds_read2_b32 v[242:243], v19 offset0:80 offset1:112
    ds_read_b32 v24, v20 offset:25600
    s_mov_b32 m0, s47
    s_add_u32 s47, s47, 1024
    buffer_load_dwordx4 v13, s[32:35], s46 offen nt lds
    s_add_u32 s46, s46, 57344
    v_lshrrev_b32 v14, 5, v4
    v_and_b32 v15, 1, v3
    v_lshl_add_u32 v15, v15, 2, v14
    v_lshlrev_b32 v15, 1, v15
    v_and_b32 v12, 31, v4
    v_xor_b32 v15, v15, v12
    v_lshl_add_u32 v14, v3, 3, v14
    v_lshlrev_b32 v12, 11, v14
    v_lshl_or_b32 v12, v15, 4, v12
    v_xor_b32 v13, 64, v12
    s_lshl_b32 s46, s44, 17
    s_lshl_b32 s47, s45, 9
    s_add_u32 s46, s46, s47
    s_cmp_ge_u32 s37, 28
    s_cselect_b32 s46, 0x40000000, s46
    s_mov_b32 s32, s22
    s_mov_b32 s33, s23
    s_lshl_b32 s47, s39, 12
    s_add_u32 s47, s47, 123904
    s_mov_b32 m0, s47
    s_add_u32 s47, s47, 1024
    buffer_load_dwordx4 v12, s[32:35], s46 offen nt lds
    s_add_u32 s46, s46, 4096
    s_waitcnt lgkmcnt(3)
    v_mfma_f32_16x16x32_bf16 v[92:95], v[236:239], v[124:127], 0
    v_mfma_f32_16x16x32_bf16 v[96:99], v[236:239], v[128:131], 0
    s_waitcnt lgkmcnt(1)
    s_nop 0
    v_mfma_f32_16x16x32_bf16 v[100:103], v[240:243], v[124:127], 0
    v_mfma_f32_16x16x32_bf16 v[104:107], v[240:243], v[128:131], 0
    v_mfma_f32_16x16x32_bf16 v[108:111], v[236:239], v[132:135], 0
    v_mfma_f32_16x16x32_bf16 v[112:115], v[236:239], v[136:139], 0
    v_mfma_f32_16x16x32_bf16 v[116:119], v[240:243], v[132:135], 0
    v_mfma_f32_16x16x32_bf16 v[120:123], v[240:243], v[136:139], 0
    s_waitcnt lgkmcnt(0)
    v_fmac_f32 v92, v22, v24
    v_pk_mul_f32 v[188:189], v[92:93], v[156:157]
    v_pk_mul_f32 v[192:193], v[96:97], v[156:157]
    v_pk_mul_f32 v[190:191], v[94:95], v[158:159]
    v_pk_mul_f32 v[194:195], v[98:99], v[158:159]
    v_pk_fma_f32 v[188:189], v[96:97], v[172:173], v[188:189] neg_lo:[1,0,0] neg_hi:[1,0,0]
    v_pk_fma_f32 v[192:193], v[92:93], v[172:173], v[192:193]
    v_pk_fma_f32 v[190:191], v[98:99], v[174:175], v[190:191] neg_lo:[1,0,0] neg_hi:[1,0,0]
    v_pk_fma_f32 v[194:195], v[94:95], v[174:175], v[194:195]
    v_cvt_pk_bf16_f32 v228, v188, v192
    v_cvt_pk_bf16_f32 v229, v189, v193
    v_cvt_pk_bf16_f32 v230, v190, v194
    v_cvt_pk_bf16_f32 v231, v191, v195
    s_nop 1
    v_mfma_f32_16x16x32_bf16 v[196:199], v[228:231], v[140:143], v[196:199]
    v_mfma_f32_16x16x32_bf16 v[204:207], v[228:231], v[148:151], v[204:207]
    s_mov_b32 m0, s47
    s_add_u32 s47, s47, 1024
    buffer_load_dwordx4 v13, s[32:35], s46 offen nt lds
    s_add_u32 s46, s46, 4096
    v_pk_mul_f32 v[60:61], v[100:101], v[160:161]
    v_pk_mul_f32 v[64:65], v[104:105], v[160:161]
    v_pk_mul_f32 v[62:63], v[102:103], v[162:163]
    v_pk_mul_f32 v[66:67], v[106:107], v[162:163]
    v_pk_fma_f32 v[60:61], v[104:105], v[176:177], v[60:61] neg_lo:[1,0,0] neg_hi:[1,0,0]
    v_pk_fma_f32 v[64:65], v[100:101], v[176:177], v[64:65]
    v_pk_fma_f32 v[62:63], v[106:107], v[178:179], v[62:63] neg_lo:[1,0,0] neg_hi:[1,0,0]
    v_pk_fma_f32 v[66:67], v[102:103], v[178:179], v[66:67]
    v_cvt_pk_bf16_f32 v232, v60, v64
    v_cvt_pk_bf16_f32 v233, v61, v65
    v_cvt_pk_bf16_f32 v234, v62, v66
    v_cvt_pk_bf16_f32 v235, v63, v67
    s_nop 1
    v_mfma_f32_16x16x32_bf16 v[196:199], v[232:235], v[144:147], v[196:199]
    v_mfma_f32_16x16x32_bf16 v[204:207], v[232:235], v[152:155], v[204:207]
    v_fmac_f32 v108, v22, v24
    v_pk_mul_f32 v[188:189], v[108:109], v[164:165]
    v_pk_mul_f32 v[192:193], v[112:113], v[164:165]
    v_pk_mul_f32 v[190:191], v[110:111], v[166:167]
    v_pk_mul_f32 v[194:195], v[114:115], v[166:167]
    v_pk_fma_f32 v[188:189], v[112:113], v[180:181], v[188:189] neg_lo:[1,0,0] neg_hi:[1,0,0]
    v_pk_fma_f32 v[192:193], v[108:109], v[180:181], v[192:193]
    v_pk_fma_f32 v[190:191], v[114:115], v[182:183], v[190:191] neg_lo:[1,0,0] neg_hi:[1,0,0]
    v_pk_fma_f32 v[194:195], v[110:111], v[182:183], v[194:195]
    v_cvt_pk_bf16_f32 v236, v188, v192
    v_cvt_pk_bf16_f32 v237, v189, v193
    v_cvt_pk_bf16_f32 v238, v190, v194
    v_cvt_pk_bf16_f32 v239, v191, v195
    s_nop 1
    s_nop 0
    v_mfma_f32_16x16x32_bf16 v[200:203], v[236:239], v[140:143], v[200:203]
    v_mfma_f32_16x16x32_bf16 v[208:211], v[236:239], v[148:151], v[208:211]
    v_pk_mul_f32 v[60:61], v[116:117], v[168:169]
    v_pk_mul_f32 v[64:65], v[120:121], v[168:169]
    v_pk_mul_f32 v[62:63], v[118:119], v[170:171]
    v_pk_mul_f32 v[66:67], v[122:123], v[170:171]
    v_pk_fma_f32 v[60:61], v[120:121], v[184:185], v[60:61] neg_lo:[1,0,0] neg_hi:[1,0,0]
    v_pk_fma_f32 v[64:65], v[116:117], v[184:185], v[64:65]
    v_pk_fma_f32 v[62:63], v[122:123], v[186:187], v[62:63] neg_lo:[1,0,0] neg_hi:[1,0,0]
    v_pk_fma_f32 v[66:67], v[118:119], v[186:187], v[66:67]
    v_cvt_pk_bf16_f32 v240, v60, v64
    v_cvt_pk_bf16_f32 v241, v61, v65
    v_cvt_pk_bf16_f32 v242, v62, v66
    v_cvt_pk_bf16_f32 v243, v63, v67
    s_nop 1
    s_nop 0
    v_mfma_f32_16x16x32_bf16 v[200:203], v[240:243], v[144:147], v[200:203]
    v_mfma_f32_16x16x32_bf16 v[208:211], v[240:243], v[152:155], v[208:211]
    v_pk_mul_f32 v[40:41], v[196:197], v[196:197]
    v_pk_mul_f32 v[42:43], v[196:197], v[212:213]
    v_pk_add_f32 v[38:39], v[198:199], v[196:197]
    v_pk_fma_f32 v[40:41], v[198:199], v[198:199], v[40:41]
    v_pk_fma_f32 v[42:43], v[198:199], v[214:215], v[42:43]
    v_pk_add_f32 v[38:39], v[38:39], v[204:205]
    v_pk_fma_f32 v[40:41], v[204:205], v[204:205], v[40:41]
    v_pk_fma_f32 v[42:43], v[204:205], v[220:221], v[42:43]
    v_pk_add_f32 v[38:39], v[38:39], v[206:207]
    v_pk_fma_f32 v[40:41], v[206:207], v[206:207], v[40:41]
    v_pk_fma_f32 v[42:43], v[206:207], v[222:223], v[42:43]
    v_pk_add_f32 v[38:39], v[38:39], v[200:201]
    v_pk_fma_f32 v[40:41], v[200:201], v[200:201], v[40:41]
    v_pk_fma_f32 v[42:43], v[200:201], v[216:217], v[42:43]
    v_pk_add_f32 v[38:39], v[38:39], v[202:203]
    v_pk_fma_f32 v[40:41], v[202:203], v[202:203], v[40:41]
    v_pk_fma_f32 v[42:43], v[202:203], v[218:219], v[42:43]
    v_pk_add_f32 v[38:39], v[38:39], v[208:209]
    v_pk_fma_f32 v[40:41], v[208:209], v[208:209], v[40:41]
    v_pk_fma_f32 v[42:43], v[208:209], v[224:225], v[42:43]
    v_pk_add_f32 v[38:39], v[38:39], v[210:211]
    v_pk_fma_f32 v[40:41], v[210:211], v[210:211], v[40:41]
    v_pk_fma_f32 v[42:43], v[210:211], v[226:227], v[42:43]
    v_add_f32 v38, v38, v39
    v_add_f32 v40, v40, v41
    v_add_f32_e64 v42, v42, v43
    v_add_f32_dpp v38, v38, v38 quad_perm:[1,0,3,2] row_mask:0xf bank_mask:0xf
    v_add_f32_dpp v40, v40, v40 quad_perm:[1,0,3,2] row_mask:0xf bank_mask:0xf
    v_add_f32_dpp v42, v42, v42 quad_perm:[1,0,3,2] row_mask:0xf bank_mask:0xf
    v_add_f32_dpp v38, v38, v38 quad_perm:[2,3,0,1] row_mask:0xf bank_mask:0xf
    v_add_f32_dpp v40, v40, v40 quad_perm:[2,3,0,1] row_mask:0xf bank_mask:0xf
    v_add_f32_dpp v42, v42, v42 quad_perm:[2,3,0,1] row_mask:0xf bank_mask:0xf
    v_add_f32_dpp v38, v38, v38 row_half_mirror row_mask:0xf bank_mask:0xf
    v_add_f32_dpp v40, v40, v40 row_half_mirror row_mask:0xf bank_mask:0xf
    v_add_f32_dpp v42, v42, v42 row_half_mirror row_mask:0xf bank_mask:0xf
    v_add_f32_dpp v38, v38, v38 row_mirror row_mask:0xf bank_mask:0xf
    v_add_f32_dpp v40, v40, v40 row_mirror row_mask:0xf bank_mask:0xf
    v_add_f32_dpp v42, v42, v42 row_mirror row_mask:0xf bank_mask:0xf
    v_add_f32_dpp v38, v38, v38 row_bcast:15 row_mask:0xa bank_mask:0xf
    v_add_f32_dpp v40, v40, v40 row_bcast:15 row_mask:0xa bank_mask:0xf
    v_add_f32_dpp v42, v42, v42 row_bcast:15 row_mask:0xa bank_mask:0xf
    v_add_f32_dpp v38, v38, v38 row_bcast:31 row_mask:0xc bank_mask:0xf
    v_add_f32_dpp v40, v40, v40 row_bcast:31 row_mask:0xc bank_mask:0xf
    v_add_f32_dpp v42, v42, v42 row_bcast:31 row_mask:0xc bank_mask:0xf
    v_mul_f32 v38, 0x3a800000, v38
    v_mul_f32 v40, 0x3a800000, v40
    v_add_f32_e64 v44, s56, v38
    v_fma_f32 v40, -v38, v38, v40
    v_cvt_pk_bf16_f32 v44, v44, v40
    v_and_b32 v40, 0xffff0000, v44
    v_lshlrev_b32 v44, 16, v44
    v_add_f32 v40, 0x3727c5ac, v40
    v_subrev_f32 v44, s56, v44
    v_cvt_pk_bf16_f32 v40, v40, v40
    v_fma_f32 v42, -v44, v25, v42
    v_and_b32 v40, 0xffff0000, v40
    v_sqrt_f32 v40, v40
    s_lshl_b32 s41, s39, 8
    v_cvt_pk_bf16_f32 v40, v40, v40
    s_add_u32 s41, s41, s38
    v_and_b32 v40, 0xffff0000, v40
    v_rcp_f32 v46, v40
    s_sub_u32 s41, 0x87ff, s41
    v_mul_f32 v42, v42, v46
    v_cvt_pk_bf16_f32 v42, v42, v42
    v_ashrrev_i32 v43, 31, v42
    v_or_b32 v43, 0x80000000, v43
    v_xor_b32 v42, v42, v43
    v_and_b32 v42, 0xffff0000, v42
    v_or_b32 v45, s41, v42
    v_lshlrev_b32 v5, 2, v3
    s_mov_b32 exec_lo, 0
    s_mov_b32 exec_hi, 0x80000000
    ds_write_b32 v5, v45 offset:58112
    s_mov_b64 exec, -1
    v_readlane_b32 s52, v44, 63
    v_readlane_b32 s54, v46, 63
    v_lshlrev_b32 v6, 2, v16
    v_lshrrev_b32 v14, 3, v4
    v_lshl_or_b32 v14, v14, 13, v6
    v_mov_b32 v5, 0
    s_lshl_b32 s41, s2, 5
    s_add_u32 s41, s41, 13631488
    s_waitcnt lgkmcnt(0)
    s_barrier
    ds_read_b32 v7, v6 offset:58112
    s_cmp_lg_u32 s39, 0
    s_cbranch_scc1 KP_NOKEY
    s_mov_b64 exec, -1
    s_waitcnt lgkmcnt(0)
    buffer_store_dword v7, v14, s[4:7], s41 offen sc1
    s_mov_b64 exec, -1
KP_NOKEY:
    s_sleep 1
    s_mov_b32 m0, s47
    s_add_u32 s47, s47, 1024
    buffer_load_dwordx4 v12, s[32:35], s46 offen nt lds
    s_add_u32 s46, s46, 4096
    s_mov_b32 m0, s47
    s_nop 0
    s_add_u32 s47, s47, 1024
    buffer_load_dwordx4 v13, s[32:35], s46 offen nt lds
    s_add_u32 s46, s46, 4096
    ds_read_b128 v[108:111], v5 offset:58112
    ds_read_b128 v[112:115], v5 offset:58128
    v_lshlrev_b32_e64 v8, 4, v0
    s_and_b32 s28, s2, 7
    s_lshl_b32 s28, s28, 13
    s_add_u32 s28, s28, 13631488
    v_pk_add_f32 v[92:93], v[196:197], s[52:53] op_sel_hi:[1,0] neg_lo:[0,1] neg_hi:[0,1]
    v_pk_add_f32 v[94:95], v[198:199], s[52:53] op_sel_hi:[1,0] neg_lo:[0,1] neg_hi:[0,1]
    v_pk_add_f32 v[96:97], v[200:201], s[52:53] op_sel_hi:[1,0] neg_lo:[0,1] neg_hi:[0,1]
    v_pk_add_f32 v[98:99], v[202:203], s[52:53] op_sel_hi:[1,0] neg_lo:[0,1] neg_hi:[0,1]
    v_pk_add_f32 v[100:101], v[204:205], s[52:53] op_sel_hi:[1,0] neg_lo:[0,1] neg_hi:[0,1]
    v_pk_add_f32 v[102:103], v[206:207], s[52:53] op_sel_hi:[1,0] neg_lo:[0,1] neg_hi:[0,1]
    v_pk_add_f32 v[104:105], v[208:209], s[52:53] op_sel_hi:[1,0] neg_lo:[0,1] neg_hi:[0,1]
    v_pk_add_f32 v[106:107], v[210:211], s[52:53] op_sel_hi:[1,0] neg_lo:[0,1] neg_hi:[0,1]
    v_pk_add_f32 v[196:197], v[196:197], s[56:57] op_sel_hi:[1,0]
    v_pk_add_f32 v[198:199], v[198:199], s[56:57] op_sel_hi:[1,0]
    v_pk_add_f32 v[200:201], v[200:201], s[56:57] op_sel_hi:[1,0]
    v_pk_add_f32 v[202:203], v[202:203], s[56:57] op_sel_hi:[1,0]
    v_pk_add_f32 v[204:205], v[204:205], s[56:57] op_sel_hi:[1,0]
    v_pk_add_f32 v[206:207], v[206:207], s[56:57] op_sel_hi:[1,0]
    v_pk_add_f32 v[208:209], v[208:209], s[56:57] op_sel_hi:[1,0]
    v_pk_add_f32 v[210:211], v[210:211], s[56:57] op_sel_hi:[1,0]
    v_pk_mul_f32 v[92:93], v[92:93], s[54:55] op_sel_hi:[1,0]
    v_pk_mul_f32 v[94:95], v[94:95], s[54:55] op_sel_hi:[1,0]
    v_pk_mul_f32 v[96:97], v[96:97], s[54:55] op_sel_hi:[1,0]
    v_pk_mul_f32 v[98:99], v[98:99], s[54:55] op_sel_hi:[1,0]
    v_pk_mul_f32 v[100:101], v[100:101], s[54:55] op_sel_hi:[1,0]
    v_pk_mul_f32 v[102:103], v[102:103], s[54:55] op_sel_hi:[1,0]
    v_pk_mul_f32 v[104:105], v[104:105], s[54:55] op_sel_hi:[1,0]
    v_pk_mul_f32 v[106:107], v[106:107], s[54:55] op_sel_hi:[1,0]
    v_cvt_pk_bf16_f32 v188, v196, v197
    v_cvt_pk_bf16_f32 v189, v198, v199
    v_cvt_pk_bf16_f32 v190, v200, v201
    v_cvt_pk_bf16_f32 v191, v202, v203
    v_cvt_pk_bf16_f32 v192, v204, v205
    v_cvt_pk_bf16_f32 v193, v206, v207
    v_cvt_pk_bf16_f32 v194, v208, v209
    v_cvt_pk_bf16_f32 v195, v210, v211
    v_cvt_pk_bf16_f32 v212, v92, v93
    v_cvt_pk_bf16_f32 v213, v94, v95
    v_cvt_pk_bf16_f32 v214, v96, v97
    v_cvt_pk_bf16_f32 v215, v98, v99
    v_cvt_pk_bf16_f32 v216, v100, v101
    v_cvt_pk_bf16_f32 v217, v102, v103
    v_cvt_pk_bf16_f32 v218, v104, v105
    v_cvt_pk_bf16_f32 v219, v106, v107
    v_pk_add_f32 v[92:93], v[92:93], v[196:197]
    v_pk_add_f32 v[94:95], v[94:95], v[198:199]
    v_pk_add_f32 v[96:97], v[96:97], v[200:201]
    v_pk_add_f32 v[98:99], v[98:99], v[202:203]
    v_pk_add_f32 v[100:101], v[100:101], v[204:205]
    v_pk_add_f32 v[102:103], v[102:103], v[206:207]
    v_pk_add_f32 v[104:105], v[104:105], v[208:209]
    v_pk_add_f32 v[106:107], v[106:107], v[210:211]
    v_cvt_pk_bf16_f32 v220, v92, v93
    v_cvt_pk_bf16_f32 v221, v94, v95
    v_cvt_pk_bf16_f32 v222, v96, v97
    v_cvt_pk_bf16_f32 v223, v98, v99
    v_cvt_pk_bf16_f32 v224, v100, v101
    v_cvt_pk_bf16_f32 v225, v102, v103
    v_cvt_pk_bf16_f32 v226, v104, v105
    v_cvt_pk_bf16_f32 v227, v106, v107
    s_lshr_b32 s41, s39, 1
    s_lshr_b32 s42, s37, 4
    s_lshl_b32 s42, s42, 2
    s_or_b32 s41, s41, s42
    s_cmp_lg_u32 s41, 2
    s_cbranch_scc1 KP_NOEO
    buffer_store_dwordx4 v[220:223], v10, s[24:27], s43 offen offset:0 sc1
    buffer_store_dwordx4 v[224:227], v10, s[24:27], s43 offen offset:1024 sc1
KP_NOEO:
    s_lshl_b32 s9, s36, 12
    s_cmp_ge_u32 s39, 4
    s_cbranch_scc1 KP_MB1
    v_lshlrev_b32 v34, 4, v4
    v_and_b32 v14, 1, v3
    v_lshl_or_b32 v34, v14, 11, v34
    v_lshrrev_b32 v14, 1, v3
    v_lshl_or_b32 v34, v14, 15, v34
    s_lshl_b32 s8, s37, 16
    s_add_u32 s8, s8, s9
    s_add_u32 s8, s8, 1024
    s_branch KP_MB2
KP_MB1:
    v_lshlrev_b32 v34, 19, v16
    v_lshl_add_u32 v34, v2, 4, v34
    v_and_b32 v14, 8, v1
    v_lshl_add_u32 v34, v14, 3, v34
    s_lshl_b32 s8, s45, 2
    s_add_u32 s8, s8, s39
    s_sub_u32 s8, s8, 4
    s_lshl_b32 s8, s8, 15
    s_add_u32 s8, s8, s9
    s_lshr_b32 s9, s37, 2
    v_and_b32 v14, 7, v16
    v_xor_b32_e64 v14, s9, v14
    v_lshl_add_u32 v34, v14, 7, v34
    s_add_u32 s9, s8, 2048
KP_MB2:
    s_cmp_ge_u32 s39, 4
    s_cbranch_scc1 KP_EA1
    v_bfe_u32 v19, v0, 2, 2
    v_and_b32_e64 v20, 1, v2
    v_bfe_u32 v14, v0, 1, 1
    v_lshl_add_u32 v14, v3, 1, v14
    v_and_b32 v18, 2, v19
    v_lshl_add_u32 v18, v20, 2, v18
    v_xor_b32 v14, v14, v18
    v_lshl_add_u32 v18, v2, 3, v19
    v_lshlrev_b32 v18, 7, v18
    v_lshl_add_u32 v18, v14, 4, v18
    v_and_b32 v14, 1, v0
    v_lshl_add_u32 v18, v14, 3, v18
    v_add_u32 v18, 58368, v18
    ds_read_b64_tr_b16 v[124:125], v18 offset:0
    ds_read_b64_tr_b16 v[126:127], v18 offset:512
    ds_read_b64_tr_b16 v[156:157], v18 offset:32768
    ds_read_b64_tr_b16 v[158:159], v18 offset:33280
    ds_read_b64_tr_b16 v[132:133], v18 offset:8192
    ds_read_b64_tr_b16 v[134:135], v18 offset:8704
    ds_read_b64_tr_b16 v[164:165], v18 offset:40960
    ds_read_b64_tr_b16 v[166:167], v18 offset:41472
    ds_read_b64_tr_b16 v[140:141], v18 offset:16384
    ds_read_b64_tr_b16 v[142:143], v18 offset:16896
    ds_read_b64_tr_b16 v[172:173], v18 offset:49152
    ds_read_b64_tr_b16 v[174:175], v18 offset:49664
    ds_read_b64_tr_b16 v[148:149], v18 offset:24576
    ds_read_b64_tr_b16 v[150:151], v18 offset:25088
    ds_read_b64_tr_b16 v[180:181], v18 offset:57344
    ds_read_b64_tr_b16 v[182:183], v18 offset:57856
    s_branch KP_EA2
KP_EA1:
    v_and_b32 v18, 3, v3
    v_lshrrev_b32 v20, 5, v4
    v_lshl_add_u32 v20, v18, 1, v20
    v_and_b32 v14, 31, v4
    v_lshlrev_b32_e64 v14, 4, v14
    v_lshl_add_u32 v19, v20, 12, v14
    v_mul_u32_u24 v20, 528, v20
    v_add_u32 v20, v20, v14
KP_EA2:
    s_cmp_lg_u32 s39, 7
    s_cbranch_scc1 KP_NORET
    s_not_b32 s41, s58
    v_mov_b32_e64 v14, s41
    v_lshlrev_b32 v15, 2, v4
    s_lshl_b32 s41, s38, 6
    s_add_u32 s41, s41, 4194304
    s_mov_b64 exec, 0xffff
    buffer_store_dword v14, v15, s[4:7], s41 offen
    v_lshlrev_b32 v15, 7, v4
    s_lshl_b32 s41, s38, 10
    s_add_u32 s41, s41, 4259840
    s_mov_b64 exec, 0xff
    buffer_store_dword v14, v15, s[4:7], s41 offen
    s_add_u32 s41, s14, 1
    v_mov_b32 v14, s41
    s_cmp_eq_u32 s2, 0
    s_cselect_b32 s41, 4227072, 0x40000000
    s_mov_b64 exec, 1
    buffer_store_dword v14, v15, s[4:7], s41 offen
    s_mov_b64 exec, -1
KP_NORET:
    s_waitcnt lgkmcnt(0)
    v_mov_b32 v15, 0
    v_cmp_gt_u32 vcc, v108, v7
    s_nop 1
    v_addc_co_u32 v15, vcc, 0, v15, vcc
    v_cmp_gt_u32 vcc, v109, v7
    s_nop 1
    v_addc_co_u32 v15, vcc, 0, v15, vcc
    v_cmp_gt_u32 vcc, v110, v7
    s_nop 1
    v_addc_co_u32 v15, vcc, 0, v15, vcc
    v_cmp_gt_u32 vcc, v111, v7
    s_nop 1
    v_addc_co_u32 v15, vcc, 0, v15, vcc
    v_cmp_gt_u32 vcc, v112, v7
    s_nop 1
    v_addc_co_u32 v15, vcc, 0, v15, vcc
    v_cmp_gt_u32 vcc, v113, v7
    s_nop 1
    v_addc_co_u32 v15, vcc, 0, v15, vcc
    v_cmp_gt_u32 vcc, v114, v7
    s_nop 1
    v_addc_co_u32 v15, vcc, 0, v15, vcc
    v_cmp_gt_u32 vcc, v115, v7
    s_nop 1
    v_addc_co_u32 v15, vcc, 0, v15, vcc
    v_lshlrev_b32 v15, 2, v15
    ds_permute_b32 v35, v15, v7
    v_readlane_b32 s42, v15, s39
    v_mov_b32 v36, 8
    s_waitcnt lgkmcnt(0)
    v_readlane_b32 s10, v35, 0
    v_readlane_b32 s11, v35, 1
    v_readlane_b32 s12, v35, 2
    v_readlane_b32 s13, v35, 3
    v_readlane_b32 s14, v35, 4
    v_readlane_b32 s15, v35, 5
    v_readlane_b32 s16, v35, 6
    v_readlane_b32 s17, v35, 7
    v_mov_b32 v35, s42
    s_movk_i32 s49, 0xff
    v_mov_b32 v55, s59
    v_and_b32 v52, s49, v55
    v_bfe_u32 v53, v55, 8, 8
    v_bfe_u32 v54, v55, 16, 8
    v_lshrrev_b32 v55, 24, v55
    buffer_load_dwordx4 v[76:79], v8, s[4:7], s28 offen sc1
    s_mov_b32 s48, 0
    s_waitcnt vmcnt(0)
    v_max3_u32 v7, v76, v77, v78
    v_max_u32 v7, v7, v79
    v_cmp_eq_u32 s[50:51], -1, v7
    s_nop 0
    s_cmp_lg_u64 s[50:51], 0
    s_cbranch_scc0 KP_K_DONE
KP_K_LOOP:
    s_mov_b64 exec, s[50:51]
    buffer_load_dwordx4 v[76:79], v8, s[4:7], s28 offen sc1
    s_mov_b64 exec, -1
    s_add_u32 s48, s48, 1
    s_cmp_gt_u32 s48, 200000
    s_waitcnt vmcnt(0)
    s_cbranch_scc1 KP_K_DONE
    v_max3_u32 v7, v76, v77, v78
    v_max_u32 v7, v7, v79
    v_cmp_eq_u32 s[50:51], -1, v7
    s_nop 0
    s_cmp_lg_u64 s[50:51], 0
    s_cbranch_scc1 KP_K_LOOP
KP_K_DONE:
    s_waitcnt lgkmcnt(0)
    v_cmp_lt_u32 s[60:61], s10, v76
    v_cmp_lt_u32 s[62:63], s10, v77
    v_cmp_lt_u32 s[64:65], s10, v78
    v_cmp_lt_u32 s[66:67], s10, v79
    s_bcnt1_i32_b64 s60, s[60:61]
    s_bcnt1_i32_b64 s62, s[62:63]
    s_bcnt1_i32_b64 s64, s[64:65]
    s_bcnt1_i32_b64 s66, s[66:67]
    s_add_u32 s60, s60, s62
    s_add_u32 s64, s64, s66
    s_add_u32 s41, s60, s64
    s_cmp_ge_u32 s41, 8
    s_cbranch_scc1 KP_RKDONE
    v_writelane_b32 v36, s41, 0
    v_cmp_lt_u32 s[60:61], s11, v76
    v_cmp_lt_u32 s[62:63], s11, v77
    v_cmp_lt_u32 s[64:65], s11, v78
    v_cmp_lt_u32 s[66:67], s11, v79
    s_bcnt1_i32_b64 s60, s[60:61]
    s_bcnt1_i32_b64 s62, s[62:63]
    s_bcnt1_i32_b64 s64, s[64:65]
    s_bcnt1_i32_b64 s66, s[66:67]
    s_add_u32 s60, s60, s62
    s_add_u32 s64, s64, s66
    s_add_u32 s41, s60, s64
    s_cmp_ge_u32 s41, 8
    s_cbranch_scc1 KP_RKDONE
    s_nop 0
    v_writelane_b32 v36, s41, 1
    v_cmp_lt_u32 s[60:61], s12, v76
    v_cmp_lt_u32 s[62:63], s12, v77
    v_cmp_lt_u32 s[64:65], s12, v78
    v_cmp_lt_u32 s[66:67], s12, v79
    s_bcnt1_i32_b64 s60, s[60:61]
    s_bcnt1_i32_b64 s62, s[62:63]
    s_bcnt1_i32_b64 s64, s[64:65]
    s_bcnt1_i32_b64 s66, s[66:67]
    s_add_u32 s60, s60, s62
    s_add_u32 s64, s64, s66
    s_add_u32 s41, s60, s64
    s_cmp_ge_u32 s41, 8
    s_cbranch_scc1 KP_RKDONE
    s_nop 0
    v_writelane_b32 v36, s41, 2
    v_cmp_lt_u32 s[60:61], s13, v76
    v_cmp_lt_u32 s[62:63], s13, v77
    v_cmp_lt_u32 s[64:65], s13, v78
    v_cmp_lt_u32 s[66:67], s13, v79
    s_bcnt1_i32_b64 s60, s[60:61]
    s_bcnt1_i32_b64 s62, s[62:63]
    s_bcnt1_i32_b64 s64, s[64:65]
    s_bcnt1_i32_b64 s66, s[66:67]
    s_add_u32 s60, s60, s62
    s_add_u32 s64, s64, s66
    s_add_u32 s41, s60, s64
    s_cmp_ge_u32 s41, 8
    s_cbranch_scc1 KP_RKDONE
    s_nop 0
    v_writelane_b32 v36, s41, 3
    v_cmp_lt_u32 s[60:61], s14, v76
    v_cmp_lt_u32 s[62:63], s14, v77
    v_cmp_lt_u32 s[64:65], s14, v78
    v_cmp_lt_u32 s[66:67], s14, v79
    s_bcnt1_i32_b64 s60, s[60:61]
    s_bcnt1_i32_b64 s62, s[62:63]
    s_bcnt1_i32_b64 s64, s[64:65]
    s_bcnt1_i32_b64 s66, s[66:67]
    s_add_u32 s60, s60, s62
    s_add_u32 s64, s64, s66
    s_add_u32 s41, s60, s64
    s_cmp_ge_u32 s41, 8
    s_cbranch_scc1 KP_RKDONE
    s_nop 0
    v_writelane_b32 v36, s41, 4
    v_cmp_lt_u32 s[60:61], s15, v76
    v_cmp_lt_u32 s[62:63], s15, v77
    v_cmp_lt_u32 s[64:65], s15, v78
    v_cmp_lt_u32 s[66:67], s15, v79
    s_bcnt1_i32_b64 s60, s[60:61]
    s_bcnt1_i32_b64 s62, s[62:63]
    s_bcnt1_i32_b64 s64, s[64:65]
    s_bcnt1_i32_b64 s66, s[66:67]
    s_add_u32 s60, s60, s62
    s_add_u32 s64, s64, s66
    s_add_u32 s41, s60, s64
    s_cmp_ge_u32 s41, 8
    s_cbranch_scc1 KP_RKDONE
    s_nop 0
    v_writelane_b32 v36, s41, 5
    v_cmp_lt_u32 s[60:61], s16, v76
    v_cmp_lt_u32 s[62:63], s16, v77
    v_cmp_lt_u32 s[64:65], s16, v78
    v_cmp_lt_u32 s[66:67], s16, v79
    s_bcnt1_i32_b64 s60, s[60:61]
    s_bcnt1_i32_b64 s62, s[62:63]
    s_bcnt1_i32_b64 s64, s[64:65]
    s_bcnt1_i32_b64 s66, s[66:67]
    s_add_u32 s60, s60, s62
    s_add_u32 s64, s64, s66
    s_add_u32 s41, s60, s64
    s_cmp_ge_u32 s41, 8
    s_cbranch_scc1 KP_RKDONE
    s_nop 0
    v_writelane_b32 v36, s41, 6
    v_cmp_lt_u32 s[60:61], s17, v76
    v_cmp_lt_u32 s[62:63], s17, v77
    v_cmp_lt_u32 s[64:65], s17, v78
    v_cmp_lt_u32 s[66:67], s17, v79
    s_bcnt1_i32_b64 s60, s[60:61]
    s_bcnt1_i32_b64 s62, s[62:63]
    s_bcnt1_i32_b64 s64, s[64:65]
    s_bcnt1_i32_b64 s66, s[66:67]
    s_add_u32 s60, s60, s62
    s_add_u32 s64, s64, s66
    s_add_u32 s41, s60, s64
    v_writelane_b32 v36, s41, 7
KP_RKDONE:
    s_mov_b64 exec, 0xff
    ds_add_u32 v6, v36 offset:58144
    s_mov_b64 exec, -1
    s_waitcnt lgkmcnt(0)
    s_barrier
    ds_read_b32 v7, v35 offset:58144
    s_waitcnt lgkmcnt(0)
    v_readfirstlane_b32 s41, v7
    s_nop 0
    s_cmp_ge_u32 s41, 8
    s_cbranch_scc1 KP_PUBDONE
    s_mov_b32 s43, 0x40000000
    s_lshl_b32 s42, s41, 12
    s_add_u32 s42, s42, 13697024
    s_lshl_b32 s41, s41, 7
    s_add_u32 s41, s41, 13729792
    buffer_store_dwordx4 v[212:215], v9, s[4:7], s42 offen sc1
    buffer_store_dwordx4 v[216:219], v9, s[4:7], s42 offen offset:1024 sc1
    buffer_store_dwordx4 v[188:191], v9, s[4:7], s42 offen offset:2048 sc1
    buffer_store_dwordx4 v[192:195], v9, s[4:7], s42 offen offset:3072 sc1
    v_mov_b32 v5, 0
    s_mov_b32 exec_lo, 0
    s_mov_b32 exec_hi, 0x80000000
    buffer_store_dword v45, v5, s[4:7], s41 offen sc1
    s_mov_b64 exec, -1
KP_PUBDONE:
    s_cmp_ge_u32 s37, 28
    s_cbranch_scc1 KP_RETZN
    v_bfe_u32 v5, v0, 2, 2
    v_and_b32 v6, 1, v2
    v_bfe_u32 v7, v0, 1, 1
    s_cmp_lt_u32 s39, 4
    s_cbranch_scc1 KP_GATEUP
KP_DOWNW:
    s_lshl_b32 s41, s45, 9
    s_add_u32 s41, s41, 13697024
    s_mov_b32 s48, 0
    s_mov_b64 s[50:51], -1
    s_sleep 8
KP_X_LOOP:
    s_mov_b64 exec, s[50:51]
    buffer_load_dwordx4 v[80:83], v19, s[4:7], s41 offen sc1
    s_mov_b64 exec, -1
    s_add_u32 s48, s48, 1
    s_cmp_gt_u32 s48, 200000
    s_waitcnt vmcnt(0)
    s_cbranch_scc1 KP_X_DONE
    v_max3_u32 v7, v80, v81, v82
    v_max_u32 v7, v7, v83
    v_cmp_eq_u32 s[50:51], -1, v7
    s_nop 0
    s_cmp_lg_u64 s[50:51], 0
    s_cbranch_scc1 KP_X_LOOP
KP_X_DONE:
    ds_write_b128 v20, v[80:83] offset:16384
    s_waitcnt lgkmcnt(0)
    s_barrier
    s_sleep 3
    v_bfe_u32 v7, v0, 1, 1
    v_and_b32_e64 v18, 3, v3
    v_lshl_add_u32 v7, v18, 3, v7
    v_lshl_add_u32 v6, v6, 2, v5
    v_lshlrev_b32 v6, 1, v6
    v_xor_b32 v7, v7, v6
    v_lshl_add_u32 v5, v2, 3, v5
    v_lshlrev_b32 v5, 9, v5
    v_lshl_add_u32 v5, v7, 4, v5
    v_and_b32 v7, 1, v0
    v_lshl_add_u32 v5, v7, 3, v5
    v_xor_b32 v46, 0, v5
    v_add_u32 v46, 123904, v46
    v_xor_b32 v47, 32, v5
    v_add_u32 v47, 123904, v47
    v_xor_b32_e64 v48, 64, v5
    v_add_u32 v48, 123904, v48
    v_xor_b32 v49, 96, v5
    v_add_u32 v49, 123904, v49
    ds_read_b64_tr_b16 v[124:125], v46 offset:0
    ds_read_b64_tr_b16 v[126:127], v46 offset:2048
    ds_read_b64_tr_b16 v[128:129], v47 offset:0
    ds_read_b64_tr_b16 v[130:131], v47 offset:2048
    ds_read_b64_tr_b16 v[132:133], v48 offset:0
    ds_read_b64_tr_b16 v[134:135], v48 offset:2048
    ds_read_b64_tr_b16 v[136:137], v49 offset:0
    ds_read_b64_tr_b16 v[138:139], v49 offset:2048
    ds_read_b64_tr_b16 v[140:141], v46 offset:16384
    ds_read_b64_tr_b16 v[142:143], v46 offset:18432
    ds_read_b64_tr_b16 v[144:145], v47 offset:16384
    ds_read_b64_tr_b16 v[146:147], v47 offset:18432
    ds_read_b64_tr_b16 v[148:149], v48 offset:16384
    ds_read_b64_tr_b16 v[150:151], v48 offset:18432
    ds_read_b64_tr_b16 v[152:153], v49 offset:16384
    ds_read_b64_tr_b16 v[154:155], v49 offset:18432
    s_mov_b32 s40, 0
    s_cmp_ge_u32 s39, 6
    s_cbranch_scc1 KP_NORED
    s_cmp_ge_u32 s37, 16
    s_cbranch_scc1 KP_NORED
    s_mov_b32 s40, 1
    s_lshl_b32 s64, s37, 1
    s_add_u32 s64, s64, s39
    s_sub_u32 s64, s64, 4
    s_lshl_b32 s41, s36, 5
    s_add_u32 s41, s41, s64
    s_lshr_b32 s60, s41, 1
    s_lshl_b32 s60, s60, 15
    s_and_b32 s41, s41, 1
    s_lshl_b32 s41, s41, 11
    s_add_u32 s60, s60, s41
    s_lshl_b32 s64, s64, 6
    s_lshl_b32 s62, s36, 12
    s_add_u32 s62, s62, s64
    s_add_u32 s62, s62, 13697024
    s_lshl_b32 s63, s36, 7
    s_add_u32 s63, s63, 13729792
    v_lshrrev_b32 v19, 3, v4
    v_lshlrev_b32 v19, 12, v19
    v_lshl_or_b32 v19, v16, 4, v19
    v_and_b32 v41, 1, v2
    v_lshlrev_b32 v41, 1, v41
    v_lshrrev_b32 v20, 1, v2
    v_or_b32 v41, v41, v20
    v_lshl_add_u32 v41, v16, 2, v41
    v_lshlrev_b32 v41, 1, v41
    v_mov_b32 v20, 0
    s_and_b32 s41, s36, 7
    s_lshl_b32 s41, s41, 7
    s_add_u32 s60, s60, s41
    s_xor_b32 s10, s60, 0
    s_xor_b32 s11, s60, 128
    s_xor_b32 s12, s60, 256
    s_xor_b32 s13, s60, 384
    s_xor_b32 s14, s60, 512
    s_xor_b32 s15, s60, 640
    s_xor_b32 s16, s60, 768
KP_NORED:
    v_and_b32_e64 v7, 8, v1
    v_cmp_ne_u32 s[54:55], 0, v7
    v_mul_u32_u24 v6, 144, v16
    v_lshl_add_u32 v6, v2, 4, v6
    s_waitcnt lgkmcnt(0)
    s_barrier
    ds_read_b128 v[228:231], v6 offset:20608
    ds_read_b128 v[232:235], v6 offset:20672
    s_waitcnt lgkmcnt(1)
    v_mfma_f32_16x16x32_bf16 v[92:95], v[124:127], v[228:231], 0
    v_mfma_f32_16x16x32_bf16 v[96:99], v[128:131], v[228:231], 0
    s_waitcnt lgkmcnt(0)
    v_mfma_f32_16x16x32_bf16 v[92:95], v[140:143], v[232:235], v[92:95]
    v_mfma_f32_16x16x32_bf16 v[96:99], v[144:147], v[232:235], v[96:99]
    v_mfma_f32_16x16x32_bf16 v[100:103], v[132:135], v[228:231], 0
    v_mfma_f32_16x16x32_bf16 v[104:107], v[136:139], v[228:231], 0
    v_mfma_f32_16x16x32_bf16 v[100:103], v[148:151], v[232:235], v[100:103]
    v_mfma_f32_16x16x32_bf16 v[104:107], v[152:155], v[232:235], v[104:107]
    s_nop 3
    s_nop 0
    v_cndmask_b32 v108, v92, v96, s[54:55]
    v_cndmask_b32 v109, v93, v97, s[54:55]
    v_cndmask_b32 v110, v94, v98, s[54:55]
    v_cndmask_b32 v111, v95, v99, s[54:55]
    v_bfi_b32 v108, s49, v52, v108
    v_bfi_b32 v109, s49, v53, v109
    v_bfi_b32 v110, s49, v54, v110
    v_bfi_b32 v111, s49, v55, v111
    buffer_store_dwordx4 v[108:111], v34, s[4:7], s8 offen sc1
    v_cndmask_b32 v112, v100, v104, s[54:55]
    v_cndmask_b32 v113, v101, v105, s[54:55]
    v_cndmask_b32 v114, v102, v106, s[54:55]
    v_cndmask_b32 v115, v103, v107, s[54:55]
    v_bfi_b32 v112, s49, v52, v112
    v_bfi_b32 v113, s49, v53, v113
    v_bfi_b32 v114, s49, v54, v114
    v_bfi_b32 v115, s49, v55, v115
    buffer_store_dwordx4 v[112:115], v34, s[4:7], s9 offen sc1
    s_cmp_eq_u32 s40, 0
    s_cbranch_scc1 KP_OUTSL
    buffer_load_dword v38, v20, s[4:7], s63 offen sc1
    buffer_load_sshort v39, v41, s[4:7], s62 offen sc1
    buffer_load_sshort v40, v41, s[4:7], s62 offen offset:2048 sc1
    s_sleep 18
    s_nop 0
    buffer_load_dwordx4 v[92:95], v19, s[4:7], s10 offen sc1
    buffer_load_dwordx4 v[96:99], v19, s[4:7], s11 offen sc1
    buffer_load_dwordx4 v[100:103], v19, s[4:7], s12 offen sc1
    buffer_load_dwordx4 v[104:107], v19, s[4:7], s13 offen sc1
    buffer_load_dwordx4 v[108:111], v19, s[4:7], s14 offen sc1
    buffer_load_dwordx4 v[112:115], v19, s[4:7], s15 offen sc1
    buffer_load_dwordx4 v[116:119], v19, s[4:7], s16 offen sc1
    s_waitcnt vmcnt(7)
    v_max3_u32 v18, v38, v39, v40
    v_cmp_eq_u32 s[50:51], -1, v18
    s_nop 0
    s_cmp_lg_u64 s[50:51], 0
    s_cbranch_scc0 KP_H_DONE
    s_mov_b32 s48, 0
    s_mov_b64 s[50:51], -1
KP_H_LOOP:
    s_mov_b64 exec, s[50:51]
    buffer_load_dword v38, v20, s[4:7], s63 offen sc1
    buffer_load_sshort v39, v41, s[4:7], s62 offen sc1
    buffer_load_sshort v40, v41, s[4:7], s62 offen offset:2048 sc1
    s_mov_b64 exec, -1
    s_add_u32 s48, s48, 1
    s_cmp_gt_u32 s48, 200000
    s_waitcnt vmcnt(0)
    s_cbranch_scc1 KP_H_DONE
    v_max3_u32 v18, v38, v39, v40
    v_cmp_eq_u32 s[50:51], -1, v18
    s_nop 0
    s_cmp_lg_u64 s[50:51], 0
    s_cbranch_scc1 KP_H_LOOP
KP_H_DONE:
    v_ashrrev_i32 v42, 31, v38
    v_not_b32 v42, v42
    v_or_b32 v42, 0x80000000, v42
    v_xor_b32_e64 v42, v42, v38
    v_and_b32 v42, 0xffff0000, v42
    v_mul_f32 v42, 0xbfb8aa3b, v42
    v_exp_f32 v42, v42
    v_and_b32 v43, 0x7ff, v38
    v_add_f32 v42, 1.0, v42
    v_rcp_f32_e64 v42, v42
    v_sub_u32 v43, 0x7ff, v43
    v_lshl_add_u32 v43, v43, 11, v41
    v_lshlrev_b32 v39, 16, v39
    v_lshlrev_b32 v40, 16, v40
    v_cvt_pk_bf16_f32 v42, v42, v42
    v_and_b32 v42, 0xffff0000, v42
    s_mov_b32 s48, 0
    s_waitcnt vmcnt(0)
    v_xor_b32 v140, v92, v52
    v_xor_b32 v141, v93, v53
    v_xor_b32 v142, v94, v54
    v_xor_b32 v143, v95, v55
    v_xor_b32 v144, v96, v52
    v_xor_b32 v145, v97, v53
    v_xor_b32 v146, v98, v54
    v_xor_b32 v147, v99, v55
    v_xor_b32 v148, v100, v52
    v_xor_b32 v149, v101, v53
    v_xor_b32 v150, v102, v54
    v_xor_b32 v151, v103, v55
    v_xor_b32 v152, v104, v52
    v_xor_b32 v153, v105, v53
    v_xor_b32 v154, v106, v54
    v_xor_b32 v155, v107, v55
    v_xor_b32 v156, v108, v52
    v_xor_b32 v157, v109, v53
    v_xor_b32 v158, v110, v54
    v_xor_b32 v159, v111, v55
    v_xor_b32 v160, v112, v52
    v_xor_b32 v161, v113, v53
    v_xor_b32 v162, v114, v54
    v_xor_b32 v163, v115, v55
    v_xor_b32 v164, v116, v52
    v_xor_b32 v165, v117, v53
    v_xor_b32 v166, v118, v54
    v_xor_b32 v167, v119, v55
    v_or3_b32 v7, v140, v141, v142
    v_or3_b32 v15, v143, v144, v145
    v_or3_b32 v7, v7, v146, v147
    v_or3_b32 v15, v15, v148, v149
    v_or3_b32 v7, v7, v150, v151
    v_or3_b32 v15, v15, v152, v153
    v_or3_b32 v7, v7, v154, v155
    v_or3_b32 v15, v15, v156, v157
    v_or3_b32 v7, v7, v158, v159
    v_or3_b32 v15, v15, v160, v161
    v_or3_b32 v7, v7, v162, v163
    v_or3_b32 v15, v15, v164, v165
    v_or3_b32 v7, v7, v166, v167
    v_bitop3_b32 v7, v7, v15, s49 bitop3:0xa8
    v_cmp_ne_u32 s[50:51], 0, v7
    s_nop 0
    s_wqm_b64 s[50:51], s[50:51]
    s_cbranch_scc0 KP_R_DONE
KP_R_LOOP:
    s_mov_b64 exec, s[50:51]
    buffer_load_dwordx4 v[92:95], v19, s[4:7], s10 offen sc1
    buffer_load_dwordx4 v[96:99], v19, s[4:7], s11 offen sc1
    buffer_load_dwordx4 v[100:103], v19, s[4:7], s12 offen sc1
    buffer_load_dwordx4 v[104:107], v19, s[4:7], s13 offen sc1
    buffer_load_dwordx4 v[108:111], v19, s[4:7], s14 offen sc1
    buffer_load_dwordx4 v[112:115], v19, s[4:7], s15 offen sc1
    buffer_load_dwordx4 v[116:119], v19, s[4:7], s16 offen sc1
    s_mov_b64 exec, -1
    s_add_u32 s48, s48, 1
    s_cmp_gt_u32 s48, 200000
    s_waitcnt vmcnt(0)
    s_cbranch_scc1 KP_R_DONE
    v_xor_b32 v140, v92, v52
    v_xor_b32 v141, v93, v53
    v_xor_b32 v142, v94, v54
    v_xor_b32 v143, v95, v55
    v_xor_b32 v144, v96, v52
    v_xor_b32 v145, v97, v53
    v_xor_b32 v146, v98, v54
    v_xor_b32 v147, v99, v55
    v_xor_b32 v148, v100, v52
    v_xor_b32 v149, v101, v53
    v_xor_b32 v150, v102, v54
    v_xor_b32 v151, v103, v55
    v_xor_b32 v152, v104, v52
    v_xor_b32 v153, v105, v53
    v_xor_b32 v154, v106, v54
    v_xor_b32 v155, v107, v55
    v_xor_b32 v156, v108, v52
    v_xor_b32 v157, v109, v53
    v_xor_b32 v158, v110, v54
    v_xor_b32 v159, v111, v55
    v_xor_b32 v160, v112, v52
    v_xor_b32 v161, v113, v53
    v_xor_b32 v162, v114, v54
    v_xor_b32 v163, v115, v55
    v_xor_b32 v164, v116, v52
    v_xor_b32 v165, v117, v53
    v_xor_b32 v166, v118, v54
    v_xor_b32 v167, v119, v55
    v_or3_b32 v7, v140, v141, v142
    v_or3_b32 v15, v143, v144, v145
    v_or3_b32 v7, v7, v146, v147
    v_or3_b32 v15, v15, v148, v149
    v_or3_b32 v7, v7, v150, v151
    v_or3_b32 v15, v15, v152, v153
    v_or3_b32 v7, v7, v154, v155
    v_or3_b32 v15, v15, v156, v157
    v_or3_b32 v7, v7, v158, v159
    v_or3_b32 v15, v15, v160, v161
    v_or3_b32 v7, v7, v162, v163
    v_or3_b32 v15, v15, v164, v165
    v_or3_b32 v7, v7, v166, v167
    v_bitop3_b32 v7, v7, v15, s49 bitop3:0xa8
    v_cmp_ne_u32 s[50:51], 0, v7
    s_nop 0
    s_wqm_b64 s[50:51], s[50:51]
    s_cbranch_scc1 KP_R_LOOP
KP_R_DONE:
    s_nop 0
    v_pk_add_f32 v[124:125], v[140:141], v[156:157]
    v_pk_add_f32 v[126:127], v[142:143], v[158:159]
    v_pk_add_f32 v[128:129], v[144:145], v[160:161]
    v_pk_add_f32 v[130:131], v[146:147], v[162:163]
    v_pk_add_f32 v[132:133], v[148:149], v[164:165]
    v_pk_add_f32 v[134:135], v[150:151], v[166:167]
    v_pk_add_f32 v[124:125], v[124:125], v[132:133]
    v_pk_add_f32 v[126:127], v[126:127], v[134:135]
    v_pk_add_f32 v[128:129], v[128:129], v[152:153]
    v_pk_add_f32 v[130:131], v[130:131], v[154:155]
    v_pk_add_f32 v[124:125], v[124:125], v[128:129]
    v_pk_add_f32 v[126:127], v[126:127], v[130:131]
    s_nop 0
    v_permlane32_swap_b32 v124, v125
    v_permlane32_swap_b32 v126, v127
    v_add_f32 v124, v124, v125
    v_add_f32_e64 v126, v126, v127
    s_nop 1
    v_permlane16_swap_b32 v124, v126
    v_add_f32 v124, v124, v126
    s_nop 1
    v_add_f32_dpp v124, v124, v124 row_ror:8 row_mask:0xf bank_mask:0xf
    v_cvt_pk_bf16_f32 v124, v124, v124
    v_and_b32 v124, 0xffff0000, v124
    v_mul_f32_e64 v124, v124, v42
    v_cvt_pk_bf16_f32 v124, v124, v124
    v_and_b32 v124, 0xffff0000, v124
    v_add_f32_e64 v124, v124, v39
    v_cvt_pk_bf16_f32 v124, v124, v124
    v_and_b32 v124, 0xffff0000, v124
    v_add_f32_e64 v124, v124, v40
    v_cvt_pk_bf16_f32 v124, v124, v124
    s_mov_b32 exec_lo, 0x00ff00ff
    s_mov_b32 exec_hi, 0x00ff00ff
    buffer_store_short v124, v43, s[24:27], s64 offen
    s_mov_b64 exec, -1
    s_branch KP_END
KP_RETZN:
    s_cmp_lg_u32 s37, 31
    s_cbranch_scc1 KP_OUTST
    s_not_b32 s41, s59
    v_mov_b32 v14, s41
    v_lshlrev_b32 v15, 2, v0
    s_lshl_b32 s41, s36, 11
    s_add_u32 s41, s41, 4210688
    buffer_store_dword v14, v15, s[4:7], s41 offen
    s_branch KP_OUTST
KP_OUTSL:
    s_sleep 6
KP_OUTST:
    buffer_store_dwordx4 v[220:223], v10, s[24:27], s43 offen offset:0 sc1
    buffer_store_dwordx4 v[224:227], v10, s[24:27], s43 offen offset:1024 sc1
    s_branch KP_END
KP_GATEUP:
    s_nop 0
    buffer_store_dwordx4 v[220:223], v10, s[24:27], s43 offen offset:0 sc1
    buffer_store_dwordx4 v[224:227], v10, s[24:27], s43 offen offset:1024 sc1
    ds_read_b64_tr_b16 v[128:129], v18 offset:4096
    ds_read_b64_tr_b16 v[130:131], v18 offset:4608
    ds_read_b64_tr_b16 v[160:161], v18 offset:36864
    ds_read_b64_tr_b16 v[162:163], v18 offset:37376
    ds_read_b64_tr_b16 v[136:137], v18 offset:12288
    ds_read_b64_tr_b16 v[138:139], v18 offset:12800
    ds_read_b64_tr_b16 v[168:169], v18 offset:45056
    ds_read_b64_tr_b16 v[170:171], v18 offset:45568
    ds_read_b64_tr_b16 v[144:145], v18 offset:20480
    ds_read_b64_tr_b16 v[146:147], v18 offset:20992
    ds_read_b64_tr_b16 v[176:177], v18 offset:53248
    ds_read_b64_tr_b16 v[178:179], v18 offset:53760
    ds_read_b64_tr_b16 v[152:153], v18 offset:28672
    ds_read_b64_tr_b16 v[154:155], v18 offset:29184
    ds_read_b64_tr_b16 v[184:185], v18 offset:61440
    ds_read_b64_tr_b16 v[186:187], v18 offset:61952
    v_mul_u32_u24 v19, 528, v16
    v_lshl_add_u32 v19, v2, 4, v19
    v_xor_b32 v34, 0x200000, v34
    s_getreg_b32 s63, hwreg(HW_REG_XCC_ID, 0, 4)
    v_xor_b32 v52, s63, v52
    v_xor_b32 v53, s63, v53
    v_xor_b32 v54, s63, v54
    v_xor_b32_e64 v55, s63, v55
    s_xor_b32 s60, s8, 0x10000
    s_xor_b32 s61, s8, 0x20000
    s_xor_b32 s62, s8, 0x30000
    v_and_b32_e64 v5, 2, v2
    v_lshl_add_u32 v5, v6, 2, v5
    v_mul_u32_u24 v5, 144, v5
    v_lshl_add_u32 v5, v1, 1, v5
    v_lshl_add_u32 v5, v3, 5, v5
    s_mov_b32 s54, 0
    s_mov_b32 s55, -1
    s_waitcnt vmcnt(63) lgkmcnt(0)
    s_barrier
    ds_read_b128 v[92:95], v19 offset:16384
    ds_read_b128 v[96:99], v19 offset:16448
    ds_read_b128 v[100:103], v19 offset:16512
    ds_read_b128 v[104:107], v19 offset:16576
    ds_read_b128 v[108:111], v19 offset:16640
    ds_read_b128 v[112:115], v19 offset:16704
    ds_read_b128 v[116:119], v19 offset:16768
    ds_read_b128 v[120:123], v19 offset:16832
    s_waitcnt lgkmcnt(7)
    v_mfma_f32_16x16x32_bf16 v[228:231], v[92:95], v[124:127], 0
    v_mfma_f32_16x16x32_bf16 v[232:235], v[92:95], v[156:159], 0
    s_waitcnt lgkmcnt(6)
    v_mfma_f32_16x16x32_bf16 v[228:231], v[96:99], v[128:131], v[228:231]
    v_mfma_f32_16x16x32_bf16 v[232:235], v[96:99], v[160:163], v[232:235]
    s_waitcnt lgkmcnt(5)
    v_mfma_f32_16x16x32_bf16 v[228:231], v[100:103], v[132:135], v[228:231]
    v_mfma_f32_16x16x32_bf16 v[232:235], v[100:103], v[164:167], v[232:235]
    s_waitcnt lgkmcnt(4)
    v_mfma_f32_16x16x32_bf16 v[228:231], v[104:107], v[136:139], v[228:231]
    v_mfma_f32_16x16x32_bf16 v[232:235], v[104:107], v[168:171], v[232:235]
    s_waitcnt lgkmcnt(3)
    v_mfma_f32_16x16x32_bf16 v[228:231], v[108:111], v[140:143], v[228:231]
    v_mfma_f32_16x16x32_bf16 v[232:235], v[108:111], v[172:175], v[232:235]
    s_waitcnt lgkmcnt(2)
    v_mfma_f32_16x16x32_bf16 v[228:231], v[112:115], v[144:147], v[228:231]
    v_mfma_f32_16x16x32_bf16 v[232:235], v[112:115], v[176:179], v[232:235]
    s_waitcnt lgkmcnt(1)
    v_mfma_f32_16x16x32_bf16 v[228:231], v[116:119], v[148:151], v[228:231]
    v_mfma_f32_16x16x32_bf16 v[232:235], v[116:119], v[180:183], v[232:235]
    s_waitcnt lgkmcnt(0)
    v_mfma_f32_16x16x32_bf16 v[228:231], v[120:123], v[152:155], v[228:231]
    v_mfma_f32_16x16x32_bf16 v[232:235], v[120:123], v[184:187], v[232:235]
    s_nop 6
    s_nop 0
    v_cndmask_b32 v236, v228, v230, s[54:55]
    v_cndmask_b32 v237, v229, v231, s[54:55]
    v_bfi_b32 v240, s49, v52, v236
    v_bfi_b32 v241, s49, v53, v237
    v_cndmask_b32 v238, v232, v234, s[54:55]
    v_cndmask_b32 v239, v233, v235, s[54:55]
    v_bfi_b32 v242, s49, v54, v238
    v_bfi_b32 v243, s49, v55, v239
    buffer_store_dwordx4 v[240:243], v34, s[4:7], s8 offen
    s_sleep 2
    s_mov_b32 s48, 0
    s_mov_b64 s[50:51], -1
KP_GA_LOOP:
    s_mov_b64 exec, s[50:51]
    buffer_load_dwordx4 v[60:63], v34, s[4:7], s60 offen sc1
    buffer_load_dwordx4 v[64:67], v34, s[4:7], s61 offen sc1
    buffer_load_dwordx4 v[68:71], v34, s[4:7], s62 offen sc1
    s_mov_b64 exec, -1
    s_add_u32 s48, s48, 1
    s_waitcnt vmcnt(0)
    v_xor_b32 v92, v60, v52
    v_xor_b32 v93, v61, v53
    v_xor_b32 v94, v62, v54
    v_xor_b32 v95, v63, v55
    v_xor_b32 v96, v64, v52
    v_xor_b32 v97, v65, v53
    v_xor_b32 v98, v66, v54
    v_xor_b32 v99, v67, v55
    v_xor_b32 v100, v68, v52
    v_xor_b32 v101, v69, v53
    v_xor_b32 v102, v70, v54
    v_xor_b32_e64 v103, v71, v55
    v_or3_b32 v7, v92, v93, v94
    v_or3_b32 v15, v95, v96, v97
    v_or3_b32 v7, v7, v98, v99
    v_or3_b32 v15, v15, v100, v101
    v_or3_b32 v7, v7, v102, v103
    v_bitop3_b32 v7, v7, v15, s49 bitop3:0xa8
    v_cmp_ne_u32 s[50:51], 0, v7
    s_nop 0
    s_wqm_b64 s[50:51], s[50:51]
    s_cbranch_scc0 KP_G_DONE
    s_cmp_lt_u32 s48, 4
    s_cbranch_scc1 KP_GA_LOOP
    v_xor_b32 v34, 0x200000, v34
    v_xor_b32 v52, s63, v52
    v_xor_b32 v53, s63, v53
    v_xor_b32 v54, s63, v54
    v_xor_b32 v55, s63, v55
    v_xor_b32 v240, s63, v240
    v_xor_b32 v241, s63, v241
    v_xor_b32 v242, s63, v242
    v_xor_b32_e64 v243, s63, v243
    buffer_store_dwordx4 v[240:243], v34, s[4:7], s8 offen sc1
KP_GB_LOOP:
    buffer_load_dwordx4 v[60:63], v34, s[4:7], s60 offen sc1
    buffer_load_dwordx4 v[64:67], v34, s[4:7], s61 offen sc1
    buffer_load_dwordx4 v[68:71], v34, s[4:7], s62 offen sc1
    s_add_u32 s48, s48, 1
    s_waitcnt vmcnt(0)
    v_xor_b32 v92, v60, v52
    v_xor_b32 v93, v61, v53
    v_xor_b32 v94, v62, v54
    v_xor_b32 v95, v63, v55
    v_xor_b32 v96, v64, v52
    v_xor_b32 v97, v65, v53
    v_xor_b32 v98, v66, v54
    v_xor_b32 v99, v67, v55
    v_xor_b32 v100, v68, v52
    v_xor_b32 v101, v69, v53
    v_xor_b32 v102, v70, v54
    v_xor_b32 v103, v71, v55
    v_or3_b32 v7, v92, v93, v94
    v_or3_b32 v15, v95, v96, v97
    v_or3_b32 v7, v7, v98, v99
    v_or3_b32 v15, v15, v100, v101
    v_or3_b32 v7, v7, v102, v103
    v_bitop3_b32 v7, v7, v15, s49 bitop3:0xa8
    v_cmp_ne_u32 s[50:51], 0, v7
    s_nop 0
    s_wqm_b64 s[50:51], s[50:51]
    s_cbranch_scc0 KP_G_DONE
    v_xor_b32 v34, 0x200000, v34
    v_xor_b32 v52, s63, v52
    v_xor_b32 v53, s63, v53
    v_xor_b32 v54, s63, v54
    v_xor_b32 v55, s63, v55
    s_cmp_lt_u32 s48, 200000
    s_cbranch_scc1 KP_GB_LOOP
KP_G_DONE:
    v_pk_add_f32 v[236:237], v[236:237], v[92:93]
    v_pk_add_f32 v[228:229], v[96:97], v[100:101]
    v_pk_add_f32 v[238:239], v[238:239], v[94:95]
    v_pk_add_f32 v[230:231], v[98:99], v[102:103]
    v_pk_add_f32 v[236:237], v[236:237], v[228:229]
    v_pk_add_f32 v[238:239], v[238:239], v[230:231]
    s_mov_b32 s41, 0xbfb8aa3b
    v_cvt_pk_bf16_f32 v232, v236, v237
    v_cvt_pk_bf16_f32 v233, v238, v239
    v_lshlrev_b32 v236, 16, v232
    v_and_b32 v237, 0xffff0000, v232
    v_mul_f32 v234, s41, v236
    v_mul_f32 v235, s41, v237
    v_exp_f32 v234, v234
    v_exp_f32 v235, v235
    v_lshlrev_b32 v238, 16, v233
    v_add_f32 v234, 1.0, v234
    v_add_f32 v235, 1.0, v235
    v_rcp_f32 v234, v234
    v_rcp_f32 v235, v235
    v_and_b32 v239, 0xffff0000, v233
    v_pk_mul_f32 v[236:237], v[236:237], v[234:235]
    v_cvt_pk_bf16_f32 v232, v236, v237
    v_lshlrev_b32_e64 v236, 16, v232
    v_and_b32 v237, 0xffff0000, v232
    v_pk_mul_f32 v[236:237], v[236:237], v[238:239]
    v_cvt_pk_bf16_f32 v232, v236, v237
    ds_write_b16 v5, v232 offset:20608
    ds_write_b16_d16_hi v5, v232 offset:20752
    s_waitcnt lgkmcnt(0)
    s_barrier
KP_END:
KP_EXIT:
    s_endpgm
.text
.p2align 8
.fill 256, 4, 0xBF800000
.section .rodata,"a"
.p2align 6
.amdhsa_kernel sequential_preLN__spectral_gfnet__moe_arch_mod__prompt_kernel
  .amdhsa_next_free_vgpr 244
  .amdhsa_next_free_sgpr 68
  .amdhsa_accum_offset 244
  .amdhsa_group_segment_fixed_size 0
  .amdhsa_kernarg_size 88
  .amdhsa_user_sgpr_count 2
  .amdhsa_user_sgpr_kernarg_segment_ptr 1
  .amdhsa_system_sgpr_workgroup_id_x 1
  .amdhsa_float_denorm_mode_32 3
.end_amdhsa_kernel
```
